```python
import torch

def _softmax(x, axis=-1):
    return torch.softmax(x, dim=axis)
def _gelu(x):
    return torch.nn.functional.gelu(x, approximate="tanh")
def _silu(x):
    return torch.nn.functional.silu(x)
def _sigmoid(x):
    return torch.sigmoid(x)
def _layernorm(x, axis=-1, eps=1e-5):
    m = x.mean(dim=axis, keepdim=True)
    v = x.var(dim=axis, keepdim=True, unbiased=False)
    return (x - m) / torch.sqrt(v + eps)
def _scatter_add(tgt, idx, src, axis=0):
    return tgt.clone().index_add_(axis, idx, src)
def _segment_sum(src, seg, n):
    out = torch.zeros((n,) + src.shape[1:], dtype=src.dtype)
    return out.index_add_(0, seg, src)
def _pad(x, pw):
    flat = tuple(v for pair in reversed(pw) for v in pair)
    return torch.nn.functional.pad(x, flat)

kernel_name = 'standalone__geglu_ffn__prompt'

def setup_inputs():

    _w = (lambda a: (lambda t: t.to(torch.bfloat16) if t.is_floating_point() else t)(torch.as_tensor(a)))
    B, S, D, F = 1, 2048, 512, 1792
    return {
        "x": _w((lambda *s: torch.randn(*s, dtype=torch.bfloat16) * 0.05)(B, S, D)),
        "w_gate": _w((lambda *s: torch.randn(*s, dtype=torch.bfloat16) * 0.05)(D, F)),
        "w_up": _w((lambda *s: torch.randn(*s, dtype=torch.bfloat16) * 0.05)(D, F)),
        "w_down": _w((lambda *s: torch.randn(*s, dtype=torch.bfloat16) * 0.05)(F, D)),
    }

def reference(x, w_gate, w_up, w_down):
    return (_gelu(x @ w_gate) * (x @ w_up)) @ w_down
```

```asm
; @launch grid=(256,1,1) block=(512,1,1) lds=163840
.amdgcn_target "amdgcn-amd-amdhsa--gfx950"
.text
.globl standalone__geglu_ffn__prompt_kernel
.p2align 8
.type standalone__geglu_ffn__prompt_kernel,@function
standalone__geglu_ffn__prompt_kernel:

    s_load_dwordx8 s[4:11], s[0:1], 0
    s_load_dwordx4 s[12:15], s[0:1], 32
    s_load_dwordx2 s[16:17], s[0:1], 48
    s_cmp_ge_u32 s2, 256
    s_cbranch_scc1 L_end
    s_getpc_b64 s[56:57]
L_pc:
    v_lshrrev_b32 v60, 6, v0
    s_and_b32 s58, s2, 0xf8
    v_add_u32 v61, s58, v60
    v_lshlrev_b32 v61, 7, v61
    v_min_u32 v61, L_last-L_pc, v61
    global_load_dword v62, v61, s[56:57]
    v_readfirstlane_b32 s3, v60
    v_and_b32 v1, 63, v0
    s_and_b32 s48, s2, 7
    s_lshr_b32 s49, s2, 3
    s_and_b32 s50, s48, 1
    s_lshl_b32 s50, s50, 2
    s_and_b32 s56, s49, 3
    s_add_u32 s50, s50, s56
    s_lshr_b32 s51, s48, 1
    s_mul_i32 s51, s51, 7
    s_lshr_b32 s57, s49, 2
    s_add_u32 s51, s51, s57
    s_add_u32 s52, s56, s57
    s_lshl_b32 s52, s52, 2
    s_and_b32 s53, s51, 3
    s_lshl_b32 s56, s56, 1
    s_cmp_eq_u32 s53, 3
    s_cselect_b32 s52, s56, s52
    s_lshl_b32 s56, s48, 2
    s_lshr_b32 s56, 321978912, s56
    s_add_u32 s52, s52, s56
    s_lshl_b32 s53, s50, 18
    s_lshl_b32 s54, s51, 7
    s_lshl_b32 s55, s3, 12
    v_lshrrev_b32 v32, 3, v1
    v_lshl_add_u32 v33, v60, 3, v32
    v_mul_u32_u24 v33, 3584, v33
    v_bfe_u32 v34, v1, 1, 2
    v_bfe_u32 v35, v1, 4, 1
    v_xor_b32 v34, v34, v35
    v_lshlrev_b32 v34, 5, v34
    v_and_b32 v35, 1, v1
    v_lshl_add_u32 v40, v35, 4, v34
    v_and_b32 v34, 1, v60
    v_lshlrev_b32 v34, 6, v34
    v_xor_b32 v34, v34, v40
    v_add_u32 v2, v33, v34
    v_mov_b32 v3, v2
    v_and_b32 v34, 7, v1
    v_lshrrev_b32 v35, 4, v1
    v_xor_b32 v34, v34, v35
    v_lshlrev_b32 v34, 4, v34
    v_lshl_add_u32 v36, v32, 10, v34
    v_lshl_add_u32 v4, v60, 14, v36
    v_add_u32 v5, 7*1024, v4
    v_xor_b32 v5, 64, v5
    s_add_u32 s56, s52, 0
    s_and_b32 s56, s56, 7
    s_mul_i32 s57, s56, 229376
    s_add_u32 s57, s57, s54
    s_lshl_b32 s56, s56, 7
    s_add_u32 m0, s55, 0
    s_add_u32 s56, s56, s53
    s_mov_b32 s22, 2099200
    s_mov_b32 s23, 0x00020000
    s_mov_b32 s26, 1835008
    s_mov_b32 s27, 0x00020000
    s_mov_b32 s30, 1836032
    s_mov_b32 s31, 0x00020000
    s_waitcnt lgkmcnt(0)
    s_mov_b32 s24, s6
    s_and_b32 s25, s7, 0xffff
    s_sub_u32 s28, s8, 1024
    s_subb_u32 s29, s9, 0
    s_and_b32 s29, s29, 0xffff
    s_sub_u32 s20, s4, 2048
    s_subb_u32 s21, s5, 0
    s_and_b32 s21, s21, 0xffff
    s_cmp_ge_u32 s49, 28
    s_cbranch_scc1 L_skip01
    buffer_load_dwordx4 v2, s[24:27], s57 offen lds
    buffer_load_dwordx4 v3, s[28:31], s57 offen offset:1024 lds
    buffer_load_dwordx4 v4, s[20:23], s56 offen offset:2048 lds
    buffer_load_dwordx4 v5, s[20:23], s56 offen offset:3072 lds
    s_branch L_skip02
L_skip01:
    v_lshlrev_b32 v23, 4, v1
    s_cmp_lg_u32 s2, 224
    s_cbranch_scc1 L_notag
    s_cmp_lg_u32 s3, 0
    s_cbranch_scc1 L_notag
    v_mov_b32 v61, 8388480
    v_mov_b32 v59, 0
    global_load_dword v63, v61, s[16:17] sc1
    s_waitcnt vmcnt(0)
    v_add_u32 v63, 0x9e3779b9, v63
    v_or_b32 v63, 1, v63
    s_mov_b64 exec, 1
    global_store_dword v59, v63, s[14:15] sc1
    global_store_dword v61, v63, s[16:17] sc1
    s_mov_b64 exec, -1
L_notag:
    s_add_u32 s65, s53, 133120
    s_add_u32 s65, s65, s55
    s_lshr_b32 s57, s48, 1
    s_lshl_b32 s56, s57, 15
    s_add_u32 s56, s56, s65
    buffer_load_dwordx4 v[128:131], v23, s[20:23], s56 offen offset:0
    buffer_load_dwordx4 v[132:135], v23, s[20:23], s56 offen offset:1024
    buffer_load_dwordx4 v[136:139], v23, s[20:23], s56 offen offset:2048
    buffer_load_dwordx4 v[140:143], v23, s[20:23], s56 offen offset:3072
L_skip02:
    s_mov_b32 s40, s16
    s_and_b32 s41, s17, 0xffff
    s_mov_b32 s42, 8851456
    s_mov_b32 s43, 0x00020000
    s_mov_b32 s32, s10
    s_and_b32 s33, s11, 0xffff
    s_mov_b32 s34, 1835008
    s_mov_b32 s35, 0x00020000
    s_mov_b32 s36, s12
    s_and_b32 s37, s13, 0xffff
    s_mov_b32 s38, 2097152
    s_mov_b32 s39, 0x00020000
    s_mov_b32 s44, s14
    s_and_b32 s45, s15, 0xffff
    s_mov_b32 s46, 256
    s_mov_b32 s47, 0x00020000
    v_lshlrev_b32 v23, 4, v1
    s_lshr_b32 s58, s3, 2
    s_mul_i32 s63, s58, 114688
    s_mul_i32 s62, s50, 1792
    s_lshl_b32 s57, s51, 2
    s_add_u32 s62, s62, s57
    s_and_b32 s57, s3, 3
    s_add_u32 s62, s62, s57
    s_lshl_b32 s62, s62, 9
    s_add_u32 s62, s62, s63
    s_lshl_b32 s56, s50, 1
    s_add_u32 s56, s56, s58
    s_lshl_b32 s56, s56, 5
    s_add_u32 s56, s56, s51
    s_lshl_b32 s56, s56, 6
    s_add_u32 s56, s56, 8388608
    s_add_u32 s18, s16, s56
    s_addc_u32 s19, s17, 0
    s_add_u32 s16, s16, 8847360
    s_addc_u32 s17, s17, 0
    v_add_u32 v6, 2048, v36
    v_add_u32 v7, 7*1024, v6
    v_xor_b32 v7, 64, v7
    v_add_u32 v8, 14*1024, v6
    v_add_u32 v9, 14*1024, v7
    s_lshr_b32 s56, s3, 2
    s_lshl_b32 s65, s56, 15
    s_add_u32 s65, s65, s53

    v_lshl_add_u32 v10, v32, 10, v40
    v_add_u32 v11, 7*1024, v10
    v_xor_b32 v11, 64, v11
    v_add_u32 v12, 14*1024, v10
    v_add_u32 v13, 14*1024, v11
    v_lshrrev_b32 v33, 5, v1
    v_lshlrev_b32 v34, 13, v33
    v_bfe_u32 v35, v1, 4, 1
    v_lshl_add_u32 v34, v35, 12, v34
    v_bfe_u32 v37, v1, 2, 2
    v_lshl_add_u32 v34, v37, 7, v34
    v_bfe_u32 v41, v1, 3, 2
    s_and_b32 s57, s3, 3
    v_xor_b32 v38, s57, v41
    v_lshl_add_u32 v34, v38, 5, v34
    v_and_b32 v38, 1, v1
    v_lshl_add_u32 v34, v38, 4, v34
    v_bfe_u32 v38, v1, 1, 1
    v_lshl_add_u32 v14, v38, 3, v34
    v_bfe_u32 v38, v1, 1, 3
    v_lshrrev_b32 v43, 4, v1
    v_xor_b32 v38, v38, v43
    v_lshlrev_b32 v38, 4, v38
    v_and_b32 v39, 15, v1
    v_lshl_add_u32 v38, v39, 7, v38

    s_lshl_b32 s57, s56, 14
    s_add_u32 s57, s57, 2048
    v_add_u32 v15, s57, v38

    v_xor_b32 v17, 64, v15
    v_xor_b32 v18, 96, v15
    v_lshrrev_b32 v38, 4, v1
    v_lshl_add_u32 v38, v38, 3, v37
    v_lshlrev_b32 v38, 7, v38
    v_lshl_add_u32 v38, v41, 5, v38
    v_and_b32 v42, 3, v1
    v_lshl_add_u32 v38, v42, 3, v38
    v_add_u32 v19, s55, v38
    v_xor_b32 v20, 32, v19
    v_xor_b32 v21, 64, v19
    v_xor_b32 v22, 96, v19
    v_mov_b32 v24, 0xc0135761
    s_mov_b32 s59, 0xbdd2d3e8
    v_mul_u32_u24 v38, 57344, v33
    v_lshl_add_u32 v38, v35, 8, v38
    v_lshl_add_u32 v28, v39, 4, v38
    s_bfe_u32 s57, s49, 0x10001
    s_mul_i32 s60, s57, 0x1122
    s_add_u32 s60, s60, 0x6410
    s_mul_i32 s61, s48, 896
    s_and_b32 s57, s49, 1
    s_lshl_b32 s57, s57, 3
    s_add_u32 s57, s57, s3
    s_mul_i32 s57, s57, 7
    s_add_u32 s61, s61, s57
    s_lshl_b32 s61, s61, 10
    s_and_b32 s57, s49, 2
    s_lshl_b32 s57, s57, 4
    s_lshl_b32 s56, s48, 6
    s_add_u32 s57, s57, s56
    s_mul_i32 s56, s3, 7
    s_lshr_b32 s56, s56, 1
    s_add_u32 s57, s57, s56
    s_lshl_b32 s57, s57, 6
    s_add_u32 s57, s57, 8388608
    v_lshl_add_u32 v29, v42, 6, s57
    s_sub_u32 s57, 8847360, s57
    s_sub_u32 s14, s16, s57
    s_subb_u32 s15, s17, 0
    s_lshl_b32 s57, s50, 7
    s_add_u32 s57, s57, 8847360
    v_lshl_add_u32 v38, v42, 2, s57
    v_cmp_le_u32 vcc, 4, v1
    s_lshl_b32 s57, s48, 7
    s_add_u32 s57, s57, 8847360
    v_cndmask_b32 v29, v29, v38, vcc
    v_lshl_add_u32 v38, v42, 2, s57
    v_cmp_le_u32 vcc, 8, v1
    s_nop 1
    v_cndmask_b32 v29, v29, v38, vcc
    v_mov_b32 v124, -1
    v_mov_b32 v125, -1
    v_mov_b32 v126, -1
    v_mov_b32 v127, -1
    v_mov_b32 v60, 2048

    s_lshr_b32 s1, s49, 2
    s_add_u32 s1, s1, 4
    s_and_b32 s1, s1, 7
    s_and_b32 s58, s49, 3
    s_lshl_b32 s58, s58, 1
    s_lshr_b32 s56, s49, 2
    s_add_u32 s58, s58, s56
    s_add_u32 s58, s58, s48
    s_cmp_ge_u32 s58, 7
    s_cselect_b32 s56, 7, 0
    s_sub_u32 s58, s58, s56
    s_mul_i32 s64, s3, 229376
    s_lshl_b32 s1, s1, 7
    s_add_u32 s64, s64, s1
    s_cmp_ge_u32 s58, 7
    s_cselect_b32 s56, 7, 0
    s_sub_u32 s58, s58, s56
    s_lshl_b32 s66, s58, 10
    s_lshl_b32 s73, s58, 15
    s_add_u32 s73, s73, s64
    s_add_u32 s58, s58, 1
    s_cmp_ge_u32 s58, 7
    s_cselect_b32 s56, 7, 0
    s_sub_u32 s58, s58, s56
    s_lshl_b32 s67, s58, 10
    s_lshl_b32 s74, s58, 15
    s_add_u32 s74, s74, s64
    s_add_u32 s58, s58, 1
    s_cmp_ge_u32 s58, 7
    s_cselect_b32 s56, 7, 0
    s_sub_u32 s58, s58, s56
    s_lshl_b32 s68, s58, 10
    s_lshl_b32 s75, s58, 15
    s_add_u32 s75, s75, s64
    s_add_u32 s58, s58, 1
    s_cmp_ge_u32 s58, 7
    s_cselect_b32 s56, 7, 0
    s_sub_u32 s58, s58, s56
    s_lshl_b32 s69, s58, 10
    s_lshl_b32 s76, s58, 15
    s_add_u32 s76, s76, s64
    s_add_u32 s58, s58, 1
    s_cmp_ge_u32 s58, 7
    s_cselect_b32 s56, 7, 0
    s_sub_u32 s58, s58, s56
    s_lshl_b32 s70, s58, 10
    s_lshl_b32 s77, s58, 15
    s_add_u32 s77, s77, s64
    s_add_u32 s58, s58, 1
    s_cmp_ge_u32 s58, 7
    s_cselect_b32 s56, 7, 0
    s_sub_u32 s58, s58, s56
    s_lshl_b32 s71, s58, 10
    s_lshl_b32 s78, s58, 15
    s_add_u32 s78, s78, s64
    s_add_u32 s58, s58, 1
    s_cmp_ge_u32 s58, 7
    s_cselect_b32 s56, 7, 0
    s_sub_u32 s58, s58, s56
    s_lshl_b32 s72, s58, 10
    s_lshl_b32 s79, s58, 15
    s_add_u32 s79, s79, s64
    s_add_u32 s58, s58, 1
    s_mov_b32 s64, 0
    s_cmp_ge_u32 s49, 28
    s_cbranch_scc1 L_idle
    s_setprio 1
    s_add_u32 s56, s52, 1
    s_and_b32 s56, s56, 7
    s_mul_i32 s57, s56, 229376
    s_add_u32 s57, s57, s54
    s_lshl_b32 s56, s56, 7
    s_add_u32 m0, s55, 131072
    s_add_u32 s56, s56, s53
    buffer_load_dwordx4 v2, s[24:27], s57 offen lds
    buffer_load_dwordx4 v3, s[28:31], s57 offen offset:1024 lds
    buffer_load_dwordx4 v4, s[20:23], s56 offen offset:2048 lds
    buffer_load_dwordx4 v5, s[20:23], s56 offen offset:3072 lds
    s_add_u32 s56, s52, 2
    s_and_b32 s56, s56, 7
    s_mul_i32 s57, s56, 229376
    s_add_u32 s57, s57, s54
    s_lshl_b32 s56, s56, 7
    s_add_u32 m0, s55, 65536
    s_add_u32 s56, s56, s53
    s_waitcnt vmcnt(4)
    s_barrier
    ds_read_b64_tr_b16 v[128:129], v14 offset:0
    ds_read_b64_tr_b16 v[130:131], v14 offset:512
    ds_read_b64_tr_b16 v[132:133], v14 offset:1024
    ds_read_b64_tr_b16 v[134:135], v14 offset:1536
    ds_read_b128 v[32:35], v15 offset:0
    ds_read_b128 v[36:39], v15 offset:4096
    buffer_load_dwordx4 v2, s[24:27], s57 offen lds
    buffer_load_dwordx4 v3, s[28:31], s57 offen offset:1024 lds
    s_waitcnt lgkmcnt(0)
    v_mfma_f32_16x16x32_bf16 v[64:67], v[128:131], v[32:35], 0
    v_mfma_f32_16x16x32_bf16 v[72:75], v[132:135], v[32:35], 0
    ds_read_b128 v[40:43], v15 offset:8192
    ds_read_b128 v[44:47], v15 offset:12288
    v_mfma_f32_16x16x32_bf16 v[68:71], v[128:131], v[36:39], 0
    v_mfma_f32_16x16x32_bf16 v[76:79], v[132:135], v[36:39], 0
    buffer_load_dwordx4 v4, s[20:23], s56 offen offset:2048 lds
    s_waitcnt lgkmcnt(0)
    v_mfma_f32_16x16x32_bf16 v[80:83], v[128:131], v[40:43], 0
    v_mfma_f32_16x16x32_bf16 v[88:91], v[132:135], v[40:43], 0
    ds_read_b64_tr_b16 v[136:137], v14 offset:16384
    ds_read_b64_tr_b16 v[138:139], v14 offset:16896
    ds_read_b64_tr_b16 v[140:141], v14 offset:17408
    ds_read_b64_tr_b16 v[142:143], v14 offset:17920
    ds_read_b128 v[32:35], v17 offset:0
    ds_read_b128 v[36:39], v17 offset:4096
    v_mfma_f32_16x16x32_bf16 v[84:87], v[128:131], v[44:47], 0
    v_mfma_f32_16x16x32_bf16 v[92:95], v[132:135], v[44:47], 0
    buffer_load_dwordx4 v5, s[20:23], s56 offen offset:3072 lds
    s_add_u32 s56, s52, 3
    s_and_b32 s56, s56, 7
    s_mul_i32 s57, s56, 229376
    s_add_u32 s57, s57, s54
    s_lshl_b32 s56, s56, 7
    s_add_u32 m0, s55, 98304
    s_add_u32 s56, s56, s53
    s_waitcnt lgkmcnt(0)
    v_mfma_f32_16x16x32_bf16 v[64:67], v[136:139], v[32:35], v[64:67]
    v_mfma_f32_16x16x32_bf16 v[72:75], v[140:143], v[32:35], v[72:75]
    ds_read_b128 v[40:43], v17 offset:8192
    ds_read_b128 v[44:47], v17 offset:12288
    buffer_load_dwordx4 v2, s[24:27], s57 offen lds
    v_add_u32 v14, 131072, v14
    v_add_u32 v15, 131072, v15
    v_add_u32 v17, 131072, v17
    v_mfma_f32_16x16x32_bf16 v[68:71], v[136:139], v[36:39], v[68:71]
    v_mfma_f32_16x16x32_bf16 v[76:79], v[140:143], v[36:39], v[76:79]
    s_waitcnt vmcnt(5)
    s_barrier
    s_waitcnt lgkmcnt(0)
    v_mfma_f32_16x16x32_bf16 v[80:83], v[136:139], v[40:43], v[80:83]
    v_mfma_f32_16x16x32_bf16 v[88:91], v[140:143], v[40:43], v[88:91]
    ds_read_b64_tr_b16 v[144:145], v14 offset:0
    ds_read_b64_tr_b16 v[146:147], v14 offset:512
    ds_read_b64_tr_b16 v[148:149], v14 offset:1024
    ds_read_b64_tr_b16 v[150:151], v14 offset:1536
    ds_read_b128 v[32:35], v15 offset:0
    ds_read_b128 v[36:39], v15 offset:4096
    buffer_load_dwordx4 v3, s[28:31], s57 offen offset:1024 lds
    v_mfma_f32_16x16x32_bf16 v[84:87], v[136:139], v[44:47], v[84:87]
    v_mfma_f32_16x16x32_bf16 v[92:95], v[140:143], v[44:47], v[92:95]
    buffer_load_dwordx4 v4, s[20:23], s56 offen offset:2048 lds
    s_waitcnt lgkmcnt(0)
    v_mfma_f32_16x16x32_bf16 v[64:67], v[144:147], v[32:35], v[64:67]
    v_mfma_f32_16x16x32_bf16 v[72:75], v[148:151], v[32:35], v[72:75]
    ds_read_b128 v[40:43], v15 offset:8192
    ds_read_b128 v[44:47], v15 offset:12288
    v_mfma_f32_16x16x32_bf16 v[68:71], v[144:147], v[36:39], v[68:71]
    v_mfma_f32_16x16x32_bf16 v[76:79], v[148:151], v[36:39], v[76:79]
    buffer_load_dwordx4 v5, s[20:23], s56 offen offset:3072 lds
    s_add_u32 s56, s52, 4
    s_and_b32 s56, s56, 7
    s_mul_i32 s57, s56, 229376
    s_add_u32 s57, s57, s54
    s_lshl_b32 s56, s56, 7
    s_add_u32 m0, s55, 32768
    s_add_u32 s56, s56, s53
    s_waitcnt lgkmcnt(0)
    v_mfma_f32_16x16x32_bf16 v[80:83], v[144:147], v[40:43], v[80:83]
    v_mfma_f32_16x16x32_bf16 v[88:91], v[148:151], v[40:43], v[88:91]
    ds_read_b64_tr_b16 v[152:153], v14 offset:16384
    ds_read_b64_tr_b16 v[154:155], v14 offset:16896
    ds_read_b64_tr_b16 v[156:157], v14 offset:17408
    ds_read_b64_tr_b16 v[158:159], v14 offset:17920
    ds_read_b128 v[32:35], v17 offset:0
    ds_read_b128 v[36:39], v17 offset:4096
    v_mfma_f32_16x16x32_bf16 v[84:87], v[144:147], v[44:47], v[84:87]
    v_mfma_f32_16x16x32_bf16 v[92:95], v[148:151], v[44:47], v[92:95]
    buffer_load_dwordx4 v2, s[24:27], s57 offen lds
    s_waitcnt lgkmcnt(0)
    v_mfma_f32_16x16x32_bf16 v[64:67], v[152:155], v[32:35], v[64:67]
    v_mfma_f32_16x16x32_bf16 v[72:75], v[156:159], v[32:35], v[72:75]
    ds_read_b128 v[40:43], v17 offset:8192
    ds_read_b128 v[44:47], v17 offset:12288
    buffer_load_dwordx4 v3, s[28:31], s57 offen offset:1024 lds
    v_add_u32 v14, 4294901760, v14
    v_add_u32 v15, 4294901760, v15
    v_add_u32 v17, 4294901760, v17
    v_mfma_f32_16x16x32_bf16 v[68:71], v[152:155], v[36:39], v[68:71]
    v_mfma_f32_16x16x32_bf16 v[76:79], v[156:159], v[36:39], v[76:79]
    s_waitcnt vmcnt(6)
    s_barrier
    s_waitcnt lgkmcnt(0)
    v_mfma_f32_16x16x32_bf16 v[80:83], v[152:155], v[40:43], v[80:83]
    v_mfma_f32_16x16x32_bf16 v[88:91], v[156:159], v[40:43], v[88:91]
    ds_read_b64_tr_b16 v[160:161], v14 offset:0
    ds_read_b64_tr_b16 v[162:163], v14 offset:512
    ds_read_b64_tr_b16 v[164:165], v14 offset:1024
    ds_read_b64_tr_b16 v[166:167], v14 offset:1536
    ds_read_b128 v[32:35], v15 offset:0
    ds_read_b128 v[36:39], v15 offset:4096
    buffer_load_dwordx4 v4, s[20:23], s56 offen offset:2048 lds
    v_mfma_f32_16x16x32_bf16 v[84:87], v[152:155], v[44:47], v[84:87]
    v_mfma_f32_16x16x32_bf16 v[92:95], v[156:159], v[44:47], v[92:95]
    buffer_load_dwordx4 v5, s[20:23], s56 offen offset:3072 lds
    s_add_u32 s56, s52, 5
    s_and_b32 s56, s56, 7
    s_mul_i32 s57, s56, 229376
    s_add_u32 s57, s57, s54
    s_lshl_b32 s56, s56, 7
    s_add_u32 m0, s55, 0
    s_add_u32 s56, s56, s53
    s_waitcnt lgkmcnt(0)
    v_mfma_f32_16x16x32_bf16 v[64:67], v[160:163], v[32:35], v[64:67]
    v_mfma_f32_16x16x32_bf16 v[72:75], v[164:167], v[32:35], v[72:75]
    ds_read_b128 v[40:43], v15 offset:8192
    ds_read_b128 v[44:47], v15 offset:12288
    v_mfma_f32_16x16x32_bf16 v[68:71], v[160:163], v[36:39], v[68:71]
    v_mfma_f32_16x16x32_bf16 v[76:79], v[164:167], v[36:39], v[76:79]
    buffer_load_dwordx4 v2, s[24:27], s57 offen lds
    s_waitcnt lgkmcnt(0)
    v_mfma_f32_16x16x32_bf16 v[80:83], v[160:163], v[40:43], v[80:83]
    v_mfma_f32_16x16x32_bf16 v[88:91], v[164:167], v[40:43], v[88:91]
    ds_read_b64_tr_b16 v[168:169], v14 offset:16384
    ds_read_b64_tr_b16 v[170:171], v14 offset:16896
    ds_read_b64_tr_b16 v[172:173], v14 offset:17408
    ds_read_b64_tr_b16 v[174:175], v14 offset:17920
    ds_read_b128 v[32:35], v17 offset:0
    ds_read_b128 v[36:39], v17 offset:4096
    v_mfma_f32_16x16x32_bf16 v[84:87], v[160:163], v[44:47], v[84:87]
    v_mfma_f32_16x16x32_bf16 v[92:95], v[164:167], v[44:47], v[92:95]
    buffer_load_dwordx4 v3, s[28:31], s57 offen offset:1024 lds
    s_waitcnt lgkmcnt(0)
    v_mfma_f32_16x16x32_bf16 v[64:67], v[168:171], v[32:35], v[64:67]
    v_mfma_f32_16x16x32_bf16 v[72:75], v[172:175], v[32:35], v[72:75]
    ds_read_b128 v[40:43], v17 offset:8192
    ds_read_b128 v[44:47], v17 offset:12288
    buffer_load_dwordx4 v4, s[20:23], s56 offen offset:2048 lds
    v_mfma_f32_16x16x32_bf16 v[68:71], v[168:171], v[36:39], v[68:71]
    v_mfma_f32_16x16x32_bf16 v[76:79], v[172:175], v[36:39], v[76:79]
    s_waitcnt vmcnt(7)
    s_barrier
    s_waitcnt lgkmcnt(0)
    v_mfma_f32_16x16x32_bf16 v[80:83], v[168:171], v[40:43], v[80:83]
    v_mfma_f32_16x16x32_bf16 v[88:91], v[172:175], v[40:43], v[88:91]
    ds_read_b64_tr_b16 v[176:177], v14 offset:32768
    ds_read_b64_tr_b16 v[178:179], v14 offset:33280
    ds_read_b64_tr_b16 v[180:181], v14 offset:33792
    ds_read_b64_tr_b16 v[182:183], v14 offset:34304
    ds_read_b128 v[32:35], v15 offset:32768
    ds_read_b128 v[36:39], v15 offset:36864
    buffer_load_dwordx4 v5, s[20:23], s56 offen offset:3072 lds
    s_add_u32 s56, s52, 6
    s_and_b32 s56, s56, 7
    s_mul_i32 s57, s56, 229376
    s_add_u32 s57, s57, s54
    s_lshl_b32 s56, s56, 7
    s_add_u32 m0, s55, 131072
    s_add_u32 s56, s56, s53
    v_mfma_f32_16x16x32_bf16 v[84:87], v[168:171], v[44:47], v[84:87]
    v_mfma_f32_16x16x32_bf16 v[92:95], v[172:175], v[44:47], v[92:95]
    buffer_load_dwordx4 v2, s[24:27], s57 offen lds
    s_waitcnt lgkmcnt(0)
    v_mfma_f32_16x16x32_bf16 v[64:67], v[176:179], v[32:35], v[64:67]
    v_mfma_f32_16x16x32_bf16 v[72:75], v[180:183], v[32:35], v[72:75]
    ds_read_b128 v[40:43], v15 offset:40960
    ds_read_b128 v[44:47], v15 offset:45056
    v_mfma_f32_16x16x32_bf16 v[68:71], v[176:179], v[36:39], v[68:71]
    v_mfma_f32_16x16x32_bf16 v[76:79], v[180:183], v[36:39], v[76:79]
    buffer_load_dwordx4 v3, s[28:31], s57 offen offset:1024 lds
    s_waitcnt lgkmcnt(0)
    v_mfma_f32_16x16x32_bf16 v[80:83], v[176:179], v[40:43], v[80:83]
    v_mfma_f32_16x16x32_bf16 v[88:91], v[180:183], v[40:43], v[88:91]
    ds_read_b64_tr_b16 v[184:185], v14 offset:49152
    ds_read_b64_tr_b16 v[186:187], v14 offset:49664
    ds_read_b64_tr_b16 v[188:189], v14 offset:50176
    ds_read_b64_tr_b16 v[190:191], v14 offset:50688
    ds_read_b128 v[32:35], v17 offset:32768
    ds_read_b128 v[36:39], v17 offset:36864
    v_mfma_f32_16x16x32_bf16 v[84:87], v[176:179], v[44:47], v[84:87]
    v_mfma_f32_16x16x32_bf16 v[92:95], v[180:183], v[44:47], v[92:95]
    buffer_load_dwordx4 v4, s[20:23], s56 offen offset:2048 lds
    s_waitcnt lgkmcnt(0)
    v_mfma_f32_16x16x32_bf16 v[64:67], v[184:187], v[32:35], v[64:67]
    v_mfma_f32_16x16x32_bf16 v[72:75], v[188:191], v[32:35], v[72:75]
    ds_read_b128 v[40:43], v17 offset:40960
    ds_read_b128 v[44:47], v17 offset:45056
    buffer_load_dwordx4 v5, s[20:23], s56 offen offset:3072 lds
    s_add_u32 s56, s52, 7
    s_and_b32 s56, s56, 7
    s_mul_i32 s57, s56, 229376
    s_add_u32 s57, s57, s54
    s_lshl_b32 s56, s56, 7
    s_add_u32 m0, s55, 65536
    s_add_u32 s56, s56, s53
    v_add_u32 v14, 4294901760, v14
    v_add_u32 v15, 4294901760, v15
    v_add_u32 v17, 4294901760, v17
    v_mfma_f32_16x16x32_bf16 v[68:71], v[184:187], v[36:39], v[68:71]
    v_mfma_f32_16x16x32_bf16 v[76:79], v[188:191], v[36:39], v[76:79]
    s_waitcnt vmcnt(8)
    s_waitcnt lgkmcnt(0)
    s_barrier
    v_mfma_f32_16x16x32_bf16 v[80:83], v[184:187], v[40:43], v[80:83]
    v_mfma_f32_16x16x32_bf16 v[88:91], v[188:191], v[40:43], v[88:91]
    ds_read_b64_tr_b16 v[192:193], v14 offset:32768
    ds_read_b64_tr_b16 v[194:195], v14 offset:33280
    ds_read_b64_tr_b16 v[196:197], v14 offset:33792
    ds_read_b64_tr_b16 v[198:199], v14 offset:34304
    ds_read_b128 v[32:35], v15 offset:32768
    ds_read_b128 v[36:39], v15 offset:36864
    buffer_load_dwordx4 v2, s[24:27], s57 offen lds
    v_mfma_f32_16x16x32_bf16 v[84:87], v[184:187], v[44:47], v[84:87]
    v_mfma_f32_16x16x32_bf16 v[92:95], v[188:191], v[44:47], v[92:95]
    buffer_load_dwordx4 v3, s[28:31], s57 offen offset:1024 lds
    s_waitcnt lgkmcnt(0)
    v_mfma_f32_16x16x32_bf16 v[64:67], v[192:195], v[32:35], v[64:67]
    v_mfma_f32_16x16x32_bf16 v[72:75], v[196:199], v[32:35], v[72:75]
    ds_read_b128 v[40:43], v15 offset:40960
    ds_read_b128 v[44:47], v15 offset:45056
    v_mfma_f32_16x16x32_bf16 v[68:71], v[192:195], v[36:39], v[68:71]
    v_mfma_f32_16x16x32_bf16 v[76:79], v[196:199], v[36:39], v[76:79]
    buffer_load_dwordx4 v4, s[20:23], s56 offen offset:2048 lds
    s_waitcnt lgkmcnt(0)
    v_mfma_f32_16x16x32_bf16 v[80:83], v[192:195], v[40:43], v[80:83]
    v_mfma_f32_16x16x32_bf16 v[88:91], v[196:199], v[40:43], v[88:91]
    ds_read_b64_tr_b16 v[200:201], v14 offset:49152
    ds_read_b64_tr_b16 v[202:203], v14 offset:49664
    ds_read_b64_tr_b16 v[204:205], v14 offset:50176
    ds_read_b64_tr_b16 v[206:207], v14 offset:50688
    ds_read_b128 v[32:35], v17 offset:32768
    ds_read_b128 v[36:39], v17 offset:36864
    v_mfma_f32_16x16x32_bf16 v[84:87], v[192:195], v[44:47], v[84:87]
    v_mfma_f32_16x16x32_bf16 v[92:95], v[196:199], v[44:47], v[92:95]
    buffer_load_dwordx4 v5, s[20:23], s56 offen offset:3072 lds
    s_and_b32 s56, s3, 3
    s_add_u32 s56, s56, s52
    s_add_u32 s56, s56, 0
    s_and_b32 s56, s56, 7
    s_lshl_b32 s56, s56, 7
    s_add_u32 s56, s56, s65
    s_add_u32 m0, s55, 98304
    s_add_u32 s56, s56, 131072
    s_waitcnt lgkmcnt(0)
    v_mfma_f32_16x16x32_bf16 v[64:67], v[200:203], v[32:35], v[64:67]
    v_mfma_f32_16x16x32_bf16 v[72:75], v[204:207], v[32:35], v[72:75]
    ds_read_b128 v[40:43], v17 offset:40960
    ds_read_b128 v[44:47], v17 offset:45056
    buffer_load_dwordx4 v6, s[20:23], s56 offen offset:0 lds
    v_mfma_f32_16x16x32_bf16 v[68:71], v[200:203], v[36:39], v[68:71]
    v_mfma_f32_16x16x32_bf16 v[76:79], v[204:207], v[36:39], v[76:79]
    s_waitcnt vmcnt(9)
    s_waitcnt lgkmcnt(0)
    s_barrier
    v_mfma_f32_16x16x32_bf16 v[80:83], v[200:203], v[40:43], v[80:83]
    v_mfma_f32_16x16x32_bf16 v[88:91], v[204:207], v[40:43], v[88:91]
    ds_read_b64_tr_b16 v[208:209], v14 offset:0
    ds_read_b64_tr_b16 v[210:211], v14 offset:512
    ds_read_b64_tr_b16 v[212:213], v14 offset:1024
    ds_read_b64_tr_b16 v[214:215], v14 offset:1536
    ds_read_b128 v[32:35], v15 offset:0
    ds_read_b128 v[36:39], v15 offset:4096
    buffer_load_dwordx4 v7, s[20:23], s56 offen offset:1024 lds
    v_mfma_f32_16x16x32_bf16 v[84:87], v[200:203], v[44:47], v[84:87]
    v_mfma_f32_16x16x32_bf16 v[92:95], v[204:207], v[44:47], v[92:95]
    buffer_load_dwordx4 v8, s[20:23], s56 offen offset:2048 lds
    s_waitcnt lgkmcnt(0)
    v_mfma_f32_16x16x32_bf16 v[64:67], v[208:211], v[32:35], v[64:67]
    v_mfma_f32_16x16x32_bf16 v[72:75], v[212:215], v[32:35], v[72:75]
    ds_read_b128 v[40:43], v15 offset:8192
    ds_read_b128 v[44:47], v15 offset:12288
    v_mfma_f32_16x16x32_bf16 v[68:71], v[208:211], v[36:39], v[68:71]
    v_mfma_f32_16x16x32_bf16 v[76:79], v[212:215], v[36:39], v[76:79]
    buffer_load_dwordx4 v9, s[20:23], s56 offen offset:3072 lds
    s_and_b32 s56, s3, 3
    s_add_u32 s56, s56, s52
    s_add_u32 s56, s56, 4
    s_and_b32 s56, s56, 7
    s_lshl_b32 s56, s56, 7
    s_add_u32 s56, s56, s65
    s_add_u32 m0, s55, 32768
    s_add_u32 s56, s56, 131072
    s_waitcnt lgkmcnt(0)
    v_mfma_f32_16x16x32_bf16 v[80:83], v[208:211], v[40:43], v[80:83]
    v_mfma_f32_16x16x32_bf16 v[88:91], v[212:215], v[40:43], v[88:91]
    ds_read_b64_tr_b16 v[216:217], v14 offset:16384
    ds_read_b64_tr_b16 v[218:219], v14 offset:16896
    ds_read_b64_tr_b16 v[220:221], v14 offset:17408
    ds_read_b64_tr_b16 v[222:223], v14 offset:17920
    ds_read_b128 v[32:35], v17 offset:0
    ds_read_b128 v[36:39], v17 offset:4096
    buffer_load_dword v31, off, s[44:47], 0 sc1
    v_mfma_f32_16x16x32_bf16 v[84:87], v[208:211], v[44:47], v[84:87]
    v_mfma_f32_16x16x32_bf16 v[92:95], v[212:215], v[44:47], v[92:95]
    buffer_load_dwordx4 v6, s[20:23], s56 offen offset:0 lds
    s_waitcnt lgkmcnt(0)
    v_mfma_f32_16x16x32_bf16 v[64:67], v[216:219], v[32:35], v[64:67]
    v_mfma_f32_16x16x32_bf16 v[72:75], v[220:223], v[32:35], v[72:75]
    ds_read_b128 v[40:43], v17 offset:8192
    ds_read_b128 v[44:47], v17 offset:12288
    buffer_load_dwordx4 v7, s[20:23], s56 offen offset:1024 lds
    v_add_u32 v14, 131072, v14
    v_add_u32 v15, 131072, v15
    v_add_u32 v17, 131072, v17
    v_mfma_f32_16x16x32_bf16 v[68:71], v[216:219], v[36:39], v[68:71]
    v_mfma_f32_16x16x32_bf16 v[76:79], v[220:223], v[36:39], v[76:79]
    s_waitcnt vmcnt(11)
    s_waitcnt lgkmcnt(0)
    s_barrier
    v_mfma_f32_16x16x32_bf16 v[80:83], v[216:219], v[40:43], v[80:83]
    v_mfma_f32_16x16x32_bf16 v[88:91], v[220:223], v[40:43], v[88:91]
    ds_read_b64_tr_b16 v[224:225], v14 offset:0
    ds_read_b64_tr_b16 v[226:227], v14 offset:512
    ds_read_b64_tr_b16 v[228:229], v14 offset:1024
    ds_read_b64_tr_b16 v[230:231], v14 offset:1536
    ds_read_b128 v[32:35], v15 offset:0
    ds_read_b128 v[36:39], v15 offset:4096
    buffer_load_dwordx4 v8, s[20:23], s56 offen offset:2048 lds
    v_mfma_f32_16x16x32_bf16 v[84:87], v[216:219], v[44:47], v[84:87]
    v_mfma_f32_16x16x32_bf16 v[92:95], v[220:223], v[44:47], v[92:95]
    buffer_load_dwordx4 v9, s[20:23], s56 offen offset:3072 lds
    s_and_b32 s56, s3, 3
    s_add_u32 s56, s56, s52
    s_add_u32 s56, s56, 0
    s_and_b32 s56, s56, 7
    s_lshl_b32 s56, s56, 7
    s_add_u32 s56, s56, s65
    s_add_u32 m0, s55, 0
    s_add_u32 s56, s56, 196608
    s_waitcnt lgkmcnt(0)
    v_mfma_f32_16x16x32_bf16 v[64:67], v[224:227], v[32:35], v[64:67]
    v_mfma_f32_16x16x32_bf16 v[72:75], v[228:231], v[32:35], v[72:75]
    ds_read_b128 v[40:43], v15 offset:8192
    ds_read_b128 v[44:47], v15 offset:12288
    v_mfma_f32_16x16x32_bf16 v[68:71], v[224:227], v[36:39], v[68:71]
    v_mfma_f32_16x16x32_bf16 v[76:79], v[228:231], v[36:39], v[76:79]
    buffer_load_dwordx4 v6, s[20:23], s56 offen offset:0 lds
    s_waitcnt lgkmcnt(0)
    v_mfma_f32_16x16x32_bf16 v[80:83], v[224:227], v[40:43], v[80:83]
    v_mfma_f32_16x16x32_bf16 v[88:91], v[228:231], v[40:43], v[88:91]
    ds_read_b64_tr_b16 v[232:233], v14 offset:16384
    ds_read_b64_tr_b16 v[234:235], v14 offset:16896
    ds_read_b64_tr_b16 v[236:237], v14 offset:17408
    ds_read_b64_tr_b16 v[238:239], v14 offset:17920
    ds_read_b128 v[32:35], v17 offset:0
    ds_read_b128 v[36:39], v17 offset:4096
    v_mfma_f32_16x16x32_bf16 v[84:87], v[224:227], v[44:47], v[84:87]
    v_mfma_f32_16x16x32_bf16 v[92:95], v[228:231], v[44:47], v[92:95]
    buffer_load_dwordx4 v7, s[20:23], s56 offen offset:1024 lds
    s_waitcnt lgkmcnt(0)
    v_mfma_f32_16x16x32_bf16 v[64:67], v[232:235], v[32:35], v[64:67]
    v_mfma_f32_16x16x32_bf16 v[72:75], v[236:239], v[32:35], v[72:75]
    ds_read_b128 v[40:43], v17 offset:8192
    ds_read_b128 v[44:47], v17 offset:12288
    buffer_load_dwordx4 v8, s[20:23], s56 offen offset:2048 lds
    v_add_u32 v14, 4294901760, v14
    v_add_u32 v15, 4294901760, v15
    v_add_u32 v17, 4294901760, v17
    v_mfma_f32_16x16x32_bf16 v[68:71], v[232:235], v[36:39], v[68:71]
    v_mfma_f32_16x16x32_bf16 v[76:79], v[236:239], v[36:39], v[76:79]
    s_waitcnt vmcnt(12)
    s_waitcnt lgkmcnt(0)
    s_barrier
    v_mfma_f32_16x16x32_bf16 v[80:83], v[232:235], v[40:43], v[80:83]
    v_mfma_f32_16x16x32_bf16 v[88:91], v[236:239], v[40:43], v[88:91]
    ds_read_b64_tr_b16 v[240:241], v14 offset:0
    ds_read_b64_tr_b16 v[242:243], v14 offset:512
    ds_read_b64_tr_b16 v[244:245], v14 offset:1024
    ds_read_b64_tr_b16 v[246:247], v14 offset:1536
    ds_read_b128 v[32:35], v15 offset:0
    ds_read_b128 v[36:39], v15 offset:4096
    buffer_load_dwordx4 v9, s[20:23], s56 offen offset:3072 lds
    s_and_b32 s56, s3, 3
    s_add_u32 s56, s56, s52
    s_add_u32 s56, s56, 4
    s_and_b32 s56, s56, 7
    s_lshl_b32 s56, s56, 7
    s_add_u32 s56, s56, s65
    s_add_u32 m0, s55, 131072
    s_add_u32 s56, s56, 196608
    v_mfma_f32_16x16x32_bf16 v[84:87], v[232:235], v[44:47], v[84:87]
    v_mfma_f32_16x16x32_bf16 v[92:95], v[236:239], v[44:47], v[92:95]
    buffer_load_dwordx4 v6, s[20:23], s56 offen offset:0 lds
    s_waitcnt lgkmcnt(0)
    v_mfma_f32_16x16x32_bf16 v[64:67], v[240:243], v[32:35], v[64:67]
    v_mfma_f32_16x16x32_bf16 v[72:75], v[244:247], v[32:35], v[72:75]
    ds_read_b128 v[40:43], v15 offset:8192
    ds_read_b128 v[44:47], v15 offset:12288
    s_waitcnt vmcnt(9)
    v_cmp_eq_u32 vcc, 0, v31
    s_cbranch_vccnz L_ini_1_spin
L_ini_1_ok:
    v_readfirstlane_b32 s0, v31
    s_bfe_u32 s58, s60, 262144
    s_mul_i32 s58, s58, 114688
    s_add_u32 s58, s58, s61
    v_add_u32 v2, s58, v23
    s_bfe_u32 s58, s60, 262148
    s_mul_i32 s58, s58, 114688
    s_add_u32 s58, s58, s61
    v_add_u32 v3, s58, v23
    s_bfe_u32 s58, s60, 262152
    s_mul_i32 s58, s58, 114688
    s_add_u32 s58, s58, s61
    v_add_u32 v4, s58, v23
    s_bfe_u32 s58, s60, 262156
    s_mul_i32 s58, s58, 114688
    s_add_u32 s58, s58, s61
    v_add_u32 v5, s58, v23
    v_mfma_f32_16x16x32_bf16 v[68:71], v[240:243], v[36:39], v[68:71]
    v_mfma_f32_16x16x32_bf16 v[76:79], v[244:247], v[36:39], v[76:79]
    buffer_load_dwordx4 v7, s[20:23], s56 offen offset:1024 lds
    s_waitcnt lgkmcnt(0)
    v_mfma_f32_16x16x32_bf16 v[80:83], v[240:243], v[40:43], v[80:83]
    v_mfma_f32_16x16x32_bf16 v[88:91], v[244:247], v[40:43], v[88:91]
    ds_read_b64_tr_b16 v[248:249], v14 offset:16384
    ds_read_b64_tr_b16 v[250:251], v14 offset:16896
    ds_read_b64_tr_b16 v[252:253], v14 offset:17408
    ds_read_b64_tr_b16 v[254:255], v14 offset:17920
    ds_read_b128 v[32:35], v17 offset:0
    ds_read_b128 v[36:39], v17 offset:4096
    v_mfma_f32_16x16x32_bf16 v[84:87], v[240:243], v[44:47], v[84:87]
    v_mfma_f32_16x16x32_bf16 v[92:95], v[244:247], v[44:47], v[92:95]
    buffer_load_dwordx4 v8, s[20:23], s56 offen offset:2048 lds
    s_waitcnt lgkmcnt(0)
    v_mfma_f32_16x16x32_bf16 v[64:67], v[248:251], v[32:35], v[64:67]
    v_mfma_f32_16x16x32_bf16 v[72:75], v[252:255], v[32:35], v[72:75]
    ds_read_b128 v[40:43], v17 offset:8192
    ds_read_b128 v[44:47], v17 offset:12288
    buffer_load_dwordx4 v9, s[20:23], s56 offen offset:3072 lds
    v_sub_u32 v15, v15, v60
    v_sub_u32 v17, v17, v60
    v_mfma_f32_16x16x32_bf16 v[68:71], v[248:251], v[36:39], v[68:71]
    v_mfma_f32_16x16x32_bf16 v[76:79], v[252:255], v[36:39], v[76:79]
    s_waitcnt vmcnt(13)
    s_waitcnt lgkmcnt(0)
    s_barrier
    v_mfma_f32_16x16x32_bf16 v[80:83], v[248:251], v[40:43], v[80:83]
    v_mfma_f32_16x16x32_bf16 v[88:91], v[252:255], v[40:43], v[88:91]
    ds_read_b128 v[32:35], v15 offset:32768
    s_add_u32 m0, s55, 65536
    s_nop 0
    buffer_load_dwordx4 v10, s[32:35], s73 offen offset:0 lds
    ds_read_b128 v[36:39], v15 offset:34816
    v_mfma_f32_16x16x32_bf16 v[84:87], v[248:251], v[44:47], v[84:87]
    v_mfma_f32_16x16x32_bf16 v[92:95], v[252:255], v[44:47], v[92:95]
    ds_read_b128 v[40:43], v17 offset:32768
    buffer_load_dwordx4 v11, s[32:35], s73 offen offset:1024 lds
    s_waitcnt lgkmcnt(2)
    v_mfma_f32_16x16x32_bf16 v[96:99], v[128:131], v[32:35], 0
    v_mfma_f32_16x16x32_bf16 v[104:107], v[132:135], v[32:35], 0
    ds_read_b128 v[44:47], v17 offset:34816
    v_mul_f32 v48, v64, v64
    v_mul_f32 v49, v65, v65
    v_mul_f32 v50, v66, v66
    v_mul_f32 v51, v67, v67
    v_mul_f32 v52, v68, v68
    v_mul_f32 v53, v69, v69
    s_waitcnt lgkmcnt(2)
    v_mfma_f32_16x16x32_bf16 v[100:103], v[128:131], v[36:39], 0
    v_mfma_f32_16x16x32_bf16 v[108:111], v[132:135], v[36:39], 0
    ds_read_b128 v[32:35], v15 offset:36864
    v_mul_f32 v54, v70, v70
    v_mul_f32 v55, v71, v71
    v_fma_f32 v48, v48, s59, v24
    v_fma_f32 v49, v49, s59, v24
    v_fma_f32 v50, v50, s59, v24
    v_fma_f32 v51, v51, s59, v24
    buffer_load_dwordx4 v12, s[32:35], s73 offen offset:2048 lds
    s_waitcnt lgkmcnt(2)
    v_mfma_f32_16x16x32_bf16 v[96:99], v[136:139], v[40:43], v[96:99]
    v_mfma_f32_16x16x32_bf16 v[104:107], v[140:143], v[40:43], v[104:107]
    ds_read_b128 v[36:39], v15 offset:38912
    v_fma_f32 v52, v52, s59, v24
    v_fma_f32 v53, v53, s59, v24
    v_fma_f32 v54, v54, s59, v24
    v_fma_f32 v55, v55, s59, v24
    v_mul_f32 v48, v48, v64
    v_mul_f32 v49, v49, v65
    s_waitcnt lgkmcnt(2)
    v_mfma_f32_16x16x32_bf16 v[100:103], v[136:139], v[44:47], v[100:103]
    v_mfma_f32_16x16x32_bf16 v[108:111], v[140:143], v[44:47], v[108:111]
    ds_read_b128 v[40:43], v17 offset:36864
    v_mul_f32 v50, v50, v66
    v_mul_f32 v51, v51, v67
    v_mul_f32 v52, v52, v68
    v_mul_f32 v53, v53, v69
    v_mul_f32 v54, v54, v70
    v_mul_f32 v55, v55, v71
    buffer_load_dwordx4 v13, s[32:35], s73 offen offset:3072 lds
    s_waitcnt lgkmcnt(2)
    v_mfma_f32_16x16x32_bf16 v[96:99], v[144:147], v[32:35], v[96:99]
    v_mfma_f32_16x16x32_bf16 v[104:107], v[148:151], v[32:35], v[104:107]
    ds_read_b128 v[44:47], v17 offset:38912
    v_exp_f32 v48, v48
    v_mul_f32 v64, v64, v72
    v_exp_f32 v49, v49
    v_mul_f32 v65, v65, v73
    v_exp_f32 v50, v50
    v_mul_f32 v66, v66, v74
    s_waitcnt lgkmcnt(2)
    v_mfma_f32_16x16x32_bf16 v[100:103], v[144:147], v[36:39], v[100:103]
    v_mfma_f32_16x16x32_bf16 v[108:111], v[148:151], v[36:39], v[108:111]
    ds_read_b128 v[32:35], v15 offset:40960
    v_exp_f32 v51, v51
    v_mul_f32 v67, v67, v75
    v_exp_f32 v52, v52
    v_mul_f32 v68, v68, v76
    v_exp_f32 v53, v53
    v_mul_f32 v69, v69, v77
    s_waitcnt lgkmcnt(2)
    v_mfma_f32_16x16x32_bf16 v[96:99], v[152:155], v[40:43], v[96:99]
    v_mfma_f32_16x16x32_bf16 v[104:107], v[156:159], v[40:43], v[104:107]
    ds_read_b128 v[36:39], v15 offset:43008
    v_exp_f32 v54, v54
    v_mul_f32 v70, v70, v78
    v_exp_f32 v55, v55
    v_mul_f32 v71, v71, v79
    v_add_f32 v48, 1.0, v48
    v_add_f32 v49, 1.0, v49
    s_waitcnt lgkmcnt(2)
    v_mfma_f32_16x16x32_bf16 v[100:103], v[152:155], v[44:47], v[100:103]
    v_mfma_f32_16x16x32_bf16 v[108:111], v[156:159], v[44:47], v[108:111]
    ds_read_b128 v[40:43], v17 offset:40960
    v_add_f32 v50, 1.0, v50
    v_add_f32 v51, 1.0, v51
    v_add_f32 v52, 1.0, v52
    v_add_f32 v53, 1.0, v53
    v_add_f32 v54, 1.0, v54
    v_add_f32 v55, 1.0, v55
    s_waitcnt lgkmcnt(2)
    v_mfma_f32_16x16x32_bf16 v[96:99], v[160:163], v[32:35], v[96:99]
    v_mfma_f32_16x16x32_bf16 v[104:107], v[164:167], v[32:35], v[104:107]
    ds_read_b128 v[44:47], v17 offset:43008
    v_rcp_f32 v48, v48
    v_rcp_f32 v49, v49
    v_rcp_f32 v50, v50
    v_rcp_f32 v51, v51
    v_rcp_f32 v52, v52
    v_rcp_f32 v53, v53
    s_waitcnt lgkmcnt(2)
    v_mfma_f32_16x16x32_bf16 v[100:103], v[160:163], v[36:39], v[100:103]
    v_mfma_f32_16x16x32_bf16 v[108:111], v[164:167], v[36:39], v[108:111]
    ds_read_b128 v[32:35], v15 offset:45056
    v_rcp_f32 v54, v54
    v_rcp_f32 v55, v55
    v_mul_f32 v48, v48, v64
    v_mul_f32 v49, v49, v65
    v_mul_f32 v50, v50, v66
    v_mul_f32 v51, v51, v67
    s_waitcnt lgkmcnt(2)
    v_mfma_f32_16x16x32_bf16 v[96:99], v[168:171], v[40:43], v[96:99]
    v_mfma_f32_16x16x32_bf16 v[104:107], v[172:175], v[40:43], v[104:107]
    ds_read_b128 v[36:39], v15 offset:47104
    v_mul_f32 v52, v52, v68
    v_mul_f32 v53, v53, v69
    v_mul_f32 v54, v54, v70
    v_mul_f32 v55, v55, v71
    v_cvt_pk_bf16_f32 v56, v48, v49
    v_cvt_pk_bf16_f32 v58, v52, v53
    s_waitcnt lgkmcnt(2)
    v_mfma_f32_16x16x32_bf16 v[100:103], v[168:171], v[44:47], v[100:103]
    v_mfma_f32_16x16x32_bf16 v[108:111], v[172:175], v[44:47], v[108:111]
    ds_read_b128 v[40:43], v17 offset:45056
    v_cvt_pk_bf16_f32 v57, v50, v51
    v_cvt_pk_bf16_f32 v59, v54, v55
    v_permlane32_swap_b32 v56, v58
    s_nop 0
    v_permlane32_swap_b32 v57, v59
    s_waitcnt lgkmcnt(2)
    v_mfma_f32_16x16x32_bf16 v[96:99], v[176:179], v[32:35], v[96:99]
    v_mfma_f32_16x16x32_bf16 v[104:107], v[180:183], v[32:35], v[104:107]
    ds_read_b128 v[44:47], v17 offset:47104
    v_add_u32 v15, 4294901760, v15
    v_add_u32 v17, 4294901760, v17
    s_add_u32 s58, s62, s63
    buffer_store_dwordx4 v[56:59], v28, s[40:43], s58 offen sc1
    v_mul_f32 v48, v80, v80
    v_mul_f32 v49, v81, v81
    v_mul_f32 v50, v82, v82
    v_mul_f32 v51, v83, v83
    v_mul_f32 v52, v84, v84
    s_waitcnt lgkmcnt(2)
    v_mfma_f32_16x16x32_bf16 v[100:103], v[176:179], v[36:39], v[100:103]
    v_mfma_f32_16x16x32_bf16 v[108:111], v[180:183], v[36:39], v[108:111]
    s_waitcnt vmcnt(13)
    s_waitcnt lgkmcnt(0)
    s_barrier
    v_mfma_f32_16x16x32_bf16 v[96:99], v[184:187], v[40:43], v[96:99]
    v_mfma_f32_16x16x32_bf16 v[104:107], v[188:191], v[40:43], v[104:107]
    ds_read_b128 v[32:35], v15 offset:32768
    v_mul_f32 v53, v85, v85
    v_mul_f32 v54, v86, v86
    v_mul_f32 v55, v87, v87
    v_fma_f32 v48, v48, s59, v24
    v_fma_f32 v49, v49, s59, v24
    s_add_u32 m0, s55, 98304
    s_nop 0
    buffer_load_dwordx4 v10, s[32:35], s74 offen offset:0 lds
    ds_read_b128 v[36:39], v15 offset:34816
    v_fma_f32 v50, v50, s59, v24
    v_fma_f32 v51, v51, s59, v24
    v_fma_f32 v52, v52, s59, v24
    v_fma_f32 v53, v53, s59, v24
    v_fma_f32 v54, v54, s59, v24
    v_mfma_f32_16x16x32_bf16 v[100:103], v[184:187], v[44:47], v[100:103]
    v_mfma_f32_16x16x32_bf16 v[108:111], v[188:191], v[44:47], v[108:111]
    ds_read_b128 v[40:43], v17 offset:32768
    v_fma_f32 v55, v55, s59, v24
    v_mul_f32 v48, v48, v80
    v_mul_f32 v49, v49, v81
    v_mul_f32 v50, v50, v82
    buffer_load_dwordx4 v11, s[32:35], s74 offen offset:1024 lds
    s_waitcnt lgkmcnt(2)
    v_mfma_f32_16x16x32_bf16 v[96:99], v[192:195], v[32:35], v[96:99]
    v_mfma_f32_16x16x32_bf16 v[104:107], v[196:199], v[32:35], v[104:107]
    ds_read_b128 v[44:47], v17 offset:34816
    v_mul_f32 v51, v51, v83
    v_mul_f32 v52, v52, v84
    v_mul_f32 v53, v53, v85
    v_mul_f32 v54, v54, v86
    v_mul_f32 v55, v55, v87
    s_waitcnt lgkmcnt(2)
    v_mfma_f32_16x16x32_bf16 v[100:103], v[192:195], v[36:39], v[100:103]
    v_mfma_f32_16x16x32_bf16 v[108:111], v[196:199], v[36:39], v[108:111]
    ds_read_b128 v[32:35], v15 offset:36864
    v_exp_f32 v48, v48
    v_mul_f32 v80, v80, v88
    v_exp_f32 v49, v49
    v_mul_f32 v81, v81, v89
    v_exp_f32 v50, v50
    buffer_load_dwordx4 v12, s[32:35], s74 offen offset:2048 lds
    s_waitcnt lgkmcnt(2)
    v_mfma_f32_16x16x32_bf16 v[96:99], v[200:203], v[40:43], v[96:99]
    v_mfma_f32_16x16x32_bf16 v[104:107], v[204:207], v[40:43], v[104:107]
    ds_read_b128 v[36:39], v15 offset:38912
    v_mul_f32 v82, v82, v90
    v_exp_f32 v51, v51
    v_mul_f32 v83, v83, v91
    v_exp_f32 v52, v52
    v_mul_f32 v84, v84, v92
    s_waitcnt lgkmcnt(2)
    v_mfma_f32_16x16x32_bf16 v[100:103], v[200:203], v[44:47], v[100:103]
    v_mfma_f32_16x16x32_bf16 v[108:111], v[204:207], v[44:47], v[108:111]
    ds_read_b128 v[40:43], v17 offset:36864
    v_exp_f32 v53, v53
    v_mul_f32 v85, v85, v93
    v_exp_f32 v54, v54
    v_mul_f32 v86, v86, v94
    buffer_load_dwordx4 v13, s[32:35], s74 offen offset:3072 lds
    s_waitcnt lgkmcnt(2)
    v_mfma_f32_16x16x32_bf16 v[96:99], v[208:211], v[32:35], v[96:99]
    v_mfma_f32_16x16x32_bf16 v[104:107], v[212:215], v[32:35], v[104:107]
    ds_read_b128 v[44:47], v17 offset:38912
    v_exp_f32 v55, v55
    v_mul_f32 v87, v87, v95
    v_add_f32 v48, 1.0, v48
    v_add_f32 v49, 1.0, v49
    v_add_f32 v50, 1.0, v50
    s_waitcnt lgkmcnt(2)
    v_mfma_f32_16x16x32_bf16 v[100:103], v[208:211], v[36:39], v[100:103]
    v_mfma_f32_16x16x32_bf16 v[108:111], v[212:215], v[36:39], v[108:111]
    ds_read_b128 v[32:35], v15 offset:40960
    v_add_f32 v51, 1.0, v51
    v_add_f32 v52, 1.0, v52
    v_add_f32 v53, 1.0, v53
    v_add_f32 v54, 1.0, v54
    v_add_f32 v55, 1.0, v55
    s_waitcnt lgkmcnt(2)
    v_mfma_f32_16x16x32_bf16 v[96:99], v[216:219], v[40:43], v[96:99]
    v_mfma_f32_16x16x32_bf16 v[104:107], v[220:223], v[40:43], v[104:107]
    ds_read_b128 v[36:39], v15 offset:43008
    v_rcp_f32 v48, v48
    v_rcp_f32 v49, v49
    v_rcp_f32 v50, v50
    v_rcp_f32 v51, v51
    v_rcp_f32 v52, v52
    s_waitcnt lgkmcnt(2)
    v_mfma_f32_16x16x32_bf16 v[100:103], v[216:219], v[44:47], v[100:103]
    v_mfma_f32_16x16x32_bf16 v[108:111], v[220:223], v[44:47], v[108:111]
    ds_read_b128 v[40:43], v17 offset:40960
    v_rcp_f32 v53, v53
    v_rcp_f32 v54, v54
    v_rcp_f32 v55, v55
    v_mul_f32 v48, v48, v80
    s_waitcnt lgkmcnt(2)
    v_mfma_f32_16x16x32_bf16 v[96:99], v[224:227], v[32:35], v[96:99]
    v_mfma_f32_16x16x32_bf16 v[104:107], v[228:231], v[32:35], v[104:107]
    ds_read_b128 v[44:47], v17 offset:43008
    v_mul_f32 v49, v49, v81
    v_mul_f32 v50, v50, v82
    v_mul_f32 v51, v51, v83
    v_mul_f32 v52, v52, v84
    v_mul_f32 v53, v53, v85
    s_waitcnt lgkmcnt(2)
    v_mfma_f32_16x16x32_bf16 v[100:103], v[224:227], v[36:39], v[100:103]
    v_mfma_f32_16x16x32_bf16 v[108:111], v[228:231], v[36:39], v[108:111]
    ds_read_b128 v[32:35], v15 offset:45056
    v_mul_f32 v54, v54, v86
    v_mul_f32 v55, v55, v87
    v_cvt_pk_bf16_f32 v56, v48, v49
    v_cvt_pk_bf16_f32 v58, v52, v53
    v_cvt_pk_bf16_f32 v57, v50, v51
    s_waitcnt lgkmcnt(2)
    v_mfma_f32_16x16x32_bf16 v[96:99], v[232:235], v[40:43], v[96:99]
    v_mfma_f32_16x16x32_bf16 v[104:107], v[236:239], v[40:43], v[104:107]
    ds_read_b128 v[36:39], v15 offset:47104
    v_cvt_pk_bf16_f32 v59, v54, v55
    v_permlane32_swap_b32 v56, v58
    s_nop 0
    v_permlane32_swap_b32 v57, v59
    s_waitcnt lgkmcnt(2)
    v_mfma_f32_16x16x32_bf16 v[100:103], v[232:235], v[44:47], v[100:103]
    v_mfma_f32_16x16x32_bf16 v[108:111], v[236:239], v[44:47], v[108:111]
    ds_read_b128 v[40:43], v17 offset:45056
    s_add_u32 s58, s62, s63
    s_add_u32 s58, s58, 114688
    buffer_store_dwordx4 v[56:59], v28, s[40:43], s58 offen sc1
    s_waitcnt lgkmcnt(2)
    v_mfma_f32_16x16x32_bf16 v[96:99], v[240:243], v[32:35], v[96:99]
    v_mfma_f32_16x16x32_bf16 v[104:107], v[244:247], v[32:35], v[104:107]
    ds_read_b128 v[44:47], v17 offset:47104
    s_waitcnt lgkmcnt(2)
    v_mfma_f32_16x16x32_bf16 v[100:103], v[240:243], v[36:39], v[100:103]
    v_mfma_f32_16x16x32_bf16 v[108:111], v[244:247], v[36:39], v[108:111]
    s_waitcnt vmcnt(14)
    s_waitcnt vmcnt(5)
    s_waitcnt lgkmcnt(0)
    s_barrier
    v_mfma_f32_16x16x32_bf16 v[96:99], v[248:251], v[40:43], v[96:99]
    v_mfma_f32_16x16x32_bf16 v[104:107], v[252:255], v[40:43], v[104:107]
    ds_read_b128 v[32:35], v15 offset:0
    s_and_b32 s58, s3, 3
    s_cbranch_scc1 L_f_2
    s_atomic_swap s0, s[18:19], 32768
L_f_2:
    s_add_u32 m0, s55, 32768
    s_nop 0
    buffer_load_dwordx4 v10, s[32:35], s75 offen offset:0 lds
    ds_read_b128 v[36:39], v15 offset:2048
    v_mfma_f32_16x16x32_bf16 v[100:103], v[248:251], v[44:47], v[100:103]
    v_mfma_f32_16x16x32_bf16 v[108:111], v[252:255], v[44:47], v[108:111]
    ds_read_b128 v[40:43], v17 offset:0
    buffer_load_dwordx4 v11, s[32:35], s75 offen offset:1024 lds
    s_waitcnt lgkmcnt(2)
    v_mfma_f32_16x16x32_bf16 v[64:67], v[128:131], v[32:35], 0
    v_mfma_f32_16x16x32_bf16 v[72:75], v[132:135], v[32:35], 0
    ds_read_b128 v[44:47], v17 offset:2048
    s_waitcnt lgkmcnt(2)
    v_mfma_f32_16x16x32_bf16 v[68:71], v[128:131], v[36:39], 0
    v_mfma_f32_16x16x32_bf16 v[76:79], v[132:135], v[36:39], 0
    ds_read_b128 v[32:35], v15 offset:4096
    buffer_load_dwordx4 v12, s[32:35], s75 offen offset:2048 lds
    s_waitcnt lgkmcnt(2)
    v_mfma_f32_16x16x32_bf16 v[64:67], v[136:139], v[40:43], v[64:67]
    v_mfma_f32_16x16x32_bf16 v[72:75], v[140:143], v[40:43], v[72:75]
    ds_read_b128 v[36:39], v15 offset:6144
    s_waitcnt lgkmcnt(2)
    v_mfma_f32_16x16x32_bf16 v[68:71], v[136:139], v[44:47], v[68:71]
    v_mfma_f32_16x16x32_bf16 v[76:79], v[140:143], v[44:47], v[76:79]
    ds_read_b128 v[40:43], v17 offset:4096
    v_mul_f32 v48, v96, v96
    v_mul_f32 v49, v97, v97
    v_mul_f32 v50, v98, v98
    v_mul_f32 v51, v99, v99
    buffer_load_dwordx4 v13, s[32:35], s75 offen offset:3072 lds
    s_waitcnt lgkmcnt(2)
    v_mfma_f32_16x16x32_bf16 v[64:67], v[144:147], v[32:35], v[64:67]
    v_mfma_f32_16x16x32_bf16 v[72:75], v[148:151], v[32:35], v[72:75]
    ds_read_b128 v[44:47], v17 offset:6144
    v_mul_f32 v52, v100, v100
    v_mul_f32 v53, v101, v101
    v_mul_f32 v54, v102, v102
    v_add_u32 v19, 65536, v19
    v_add_u32 v20, 65536, v20
    v_add_u32 v21, 65536, v21
    v_add_u32 v22, 65536, v22
    ds_read_b64_tr_b16 v[128:129], v19 offset:0
    ds_read_b64_tr_b16 v[130:131], v19 offset:512
    s_waitcnt lgkmcnt(4)
    v_mfma_f32_16x16x32_bf16 v[68:71], v[144:147], v[36:39], v[68:71]
    v_mfma_f32_16x16x32_bf16 v[76:79], v[148:151], v[36:39], v[76:79]
    ds_read_b128 v[32:35], v15 offset:8192
    v_mul_f32 v55, v103, v103
    v_fma_f32 v48, v48, s59, v24
    v_fma_f32 v49, v49, s59, v24
    ds_read_b64_tr_b16 v[132:133], v20 offset:0
    ds_read_b64_tr_b16 v[134:135], v20 offset:512
    s_waitcnt lgkmcnt(6)
    v_mfma_f32_16x16x32_bf16 v[64:67], v[152:155], v[40:43], v[64:67]
    v_mfma_f32_16x16x32_bf16 v[72:75], v[156:159], v[40:43], v[72:75]
    ds_read_b128 v[36:39], v15 offset:10240
    v_fma_f32 v50, v50, s59, v24
    v_fma_f32 v51, v51, s59, v24
    v_fma_f32 v52, v52, s59, v24
    ds_read_b64_tr_b16 v[136:137], v21 offset:0
    ds_read_b64_tr_b16 v[138:139], v21 offset:512
    s_waitcnt lgkmcnt(8)
    v_mfma_f32_16x16x32_bf16 v[68:71], v[152:155], v[44:47], v[68:71]
    v_mfma_f32_16x16x32_bf16 v[76:79], v[156:159], v[44:47], v[76:79]
    ds_read_b128 v[40:43], v17 offset:8192
    v_fma_f32 v53, v53, s59, v24
    v_fma_f32 v54, v54, s59, v24
    v_fma_f32 v55, v55, s59, v24
    ds_read_b64_tr_b16 v[140:141], v22 offset:0
    ds_read_b64_tr_b16 v[142:143], v22 offset:512
    s_waitcnt lgkmcnt(8)
    v_mfma_f32_16x16x32_bf16 v[64:67], v[160:163], v[32:35], v[64:67]
    v_mfma_f32_16x16x32_bf16 v[72:75], v[164:167], v[32:35], v[72:75]
    ds_read_b128 v[44:47], v17 offset:10240
    v_mul_f32 v48, v48, v96
    v_mul_f32 v49, v49, v97
    v_mul_f32 v50, v50, v98
    s_waitcnt lgkmcnt(6)
    v_mfma_f32_16x16x32_bf16 v[68:71], v[160:163], v[36:39], v[68:71]
    v_mfma_f32_16x16x32_bf16 v[76:79], v[164:167], v[36:39], v[76:79]
    ds_read_b128 v[32:35], v15 offset:12288
    v_mul_f32 v51, v51, v99
    v_mul_f32 v52, v52, v100
    v_mul_f32 v53, v53, v101
    s_waitcnt lgkmcnt(2)
    s_add_u32 m0, s55, 65536
    s_nop 0
    buffer_load_dwordx4 v10, s[32:35], s77 offen offset:0 lds
    v_mfma_f32_16x16x32_bf16 v[64:67], v[168:171], v[40:43], v[64:67]
    v_mfma_f32_16x16x32_bf16 v[72:75], v[172:175], v[40:43], v[72:75]
    ds_read_b128 v[36:39], v15 offset:14336
    v_mul_f32 v54, v54, v102
    v_mul_f32 v55, v55, v103
    v_exp_f32 v48, v48
    buffer_load_dwordx4 v11, s[32:35], s77 offen offset:1024 lds
    s_waitcnt lgkmcnt(2)
    v_mfma_f32_16x16x32_bf16 v[68:71], v[168:171], v[44:47], v[68:71]
    v_mfma_f32_16x16x32_bf16 v[76:79], v[172:175], v[44:47], v[76:79]
    ds_read_b128 v[40:43], v17 offset:12288
    v_mul_f32 v96, v96, v104
    v_exp_f32 v49, v49
    v_mul_f32 v97, v97, v105
    buffer_load_dwordx4 v12, s[32:35], s77 offen offset:2048 lds
    s_waitcnt lgkmcnt(2)
    v_mfma_f32_16x16x32_bf16 v[64:67], v[176:179], v[32:35], v[64:67]
    v_mfma_f32_16x16x32_bf16 v[72:75], v[180:183], v[32:35], v[72:75]
    ds_read_b128 v[44:47], v17 offset:14336
    v_add_u32 v15, 131072, v15
    v_add_u32 v17, 131072, v17
    v_exp_f32 v50, v50
    v_mul_f32 v98, v98, v106
    v_exp_f32 v51, v51
    buffer_load_dwordx4 v13, s[32:35], s77 offen offset:3072 lds
    s_waitcnt lgkmcnt(2)
    v_mfma_f32_16x16x32_bf16 v[68:71], v[176:179], v[36:39], v[68:71]
    v_mfma_f32_16x16x32_bf16 v[76:79], v[180:183], v[36:39], v[76:79]
    s_waitcnt vmcnt(8)
    s_waitcnt lgkmcnt(0)
    s_barrier
    v_mfma_f32_16x16x32_bf16 v[64:67], v[184:187], v[40:43], v[64:67]
    v_mfma_f32_16x16x32_bf16 v[72:75], v[188:191], v[40:43], v[72:75]
    ds_read_b128 v[32:35], v15 offset:0
    s_and_b32 s58, s3, 3
    s_cbranch_scc1 L_f_3
    s_atomic_swap s0, s[18:19], 0
L_f_3:
    v_mul_f32 v99, v99, v107
    v_exp_f32 v52, v52
    v_mul_f32 v100, v100, v108
    s_add_u32 m0, s55, 0
    s_nop 0
    buffer_load_dwordx4 v10, s[32:35], s76 offen offset:0 lds
    ds_read_b128 v[36:39], v15 offset:2048
    v_exp_f32 v53, v53
    v_mul_f32 v101, v101, v109
    v_exp_f32 v54, v54
    ds_read_b64_tr_b16 v[144:145], v19 offset:32768
    ds_read_b64_tr_b16 v[146:147], v19 offset:33280
    v_mfma_f32_16x16x32_bf16 v[68:71], v[184:187], v[44:47], v[68:71]
    v_mfma_f32_16x16x32_bf16 v[76:79], v[188:191], v[44:47], v[76:79]
    ds_read_b128 v[40:43], v17 offset:0
    v_mul_f32 v102, v102, v110
    v_exp_f32 v55, v55
    v_mul_f32 v103, v103, v111
    v_add_f32 v48, 1.0, v48
    buffer_load_dwordx4 v11, s[32:35], s76 offen offset:1024 lds
    ds_read_b64_tr_b16 v[148:149], v20 offset:32768
    ds_read_b64_tr_b16 v[150:151], v20 offset:33280
    s_waitcnt lgkmcnt(6)
    v_mfma_f32_16x16x32_bf16 v[64:67], v[192:195], v[32:35], v[64:67]
    v_mfma_f32_16x16x32_bf16 v[72:75], v[196:199], v[32:35], v[72:75]
    ds_read_b128 v[44:47], v17 offset:2048
    v_add_f32 v49, 1.0, v49
    v_add_f32 v50, 1.0, v50
    v_add_f32 v51, 1.0, v51
    ds_read_b64_tr_b16 v[152:153], v21 offset:32768
    ds_read_b64_tr_b16 v[154:155], v21 offset:33280
    s_waitcnt lgkmcnt(8)
    v_mfma_f32_16x16x32_bf16 v[68:71], v[192:195], v[36:39], v[68:71]
    v_mfma_f32_16x16x32_bf16 v[76:79], v[196:199], v[36:39], v[76:79]
    ds_read_b128 v[32:35], v15 offset:4096
    v_add_f32 v52, 1.0, v52
    v_add_f32 v53, 1.0, v53
    v_add_f32 v54, 1.0, v54
    buffer_load_dwordx4 v12, s[32:35], s76 offen offset:2048 lds
    ds_read_b64_tr_b16 v[156:157], v22 offset:32768
    ds_read_b64_tr_b16 v[158:159], v22 offset:33280
    s_waitcnt lgkmcnt(8)
    v_mfma_f32_16x16x32_bf16 v[64:67], v[200:203], v[40:43], v[64:67]
    v_mfma_f32_16x16x32_bf16 v[72:75], v[204:207], v[40:43], v[72:75]
    ds_read_b128 v[36:39], v15 offset:6144
    v_add_f32 v55, 1.0, v55
    v_rcp_f32 v48, v48
    v_rcp_f32 v49, v49
    buffer_load_dwordx4 v13, s[32:35], s76 offen offset:3072 lds
    s_waitcnt lgkmcnt(6)
    v_mfma_f32_16x16x32_bf16 v[68:71], v[200:203], v[44:47], v[68:71]
    v_mfma_f32_16x16x32_bf16 v[76:79], v[204:207], v[44:47], v[76:79]
    ds_read_b128 v[40:43], v17 offset:4096
    v_rcp_f32 v50, v50
    v_rcp_f32 v51, v51
    v_rcp_f32 v52, v52
    s_waitcnt vmcnt(8)
    v_add_u32 v19, 4294901760, v19
    v_add_u32 v20, 4294901760, v20
    v_add_u32 v21, 4294901760, v21
    v_add_u32 v22, 4294901760, v22
    ds_read_b64_tr_b16 v[160:161], v19 offset:32768
    ds_read_b64_tr_b16 v[162:163], v19 offset:33280
    s_waitcnt lgkmcnt(6)
    v_mfma_f32_16x16x32_bf16 v[64:67], v[208:211], v[32:35], v[64:67]
    v_mfma_f32_16x16x32_bf16 v[72:75], v[212:215], v[32:35], v[72:75]
    ds_read_b128 v[44:47], v17 offset:6144
    v_rcp_f32 v53, v53
    v_rcp_f32 v54, v54
    v_rcp_f32 v55, v55
    s_waitcnt lgkmcnt(5)
    s_add_u32 m0, s55, 98304
    s_nop 0
    buffer_load_dwordx4 v10, s[32:35], s78 offen offset:0 lds
    ds_read_b64_tr_b16 v[164:165], v20 offset:32768
    ds_read_b64_tr_b16 v[166:167], v20 offset:33280
    s_waitcnt lgkmcnt(6)
    v_mfma_f32_16x16x32_bf16 v[68:71], v[208:211], v[36:39], v[68:71]
    v_mfma_f32_16x16x32_bf16 v[76:79], v[212:215], v[36:39], v[76:79]
    ds_read_b128 v[32:35], v15 offset:8192
    v_mul_f32 v48, v48, v96
    v_mul_f32 v49, v49, v97
    v_mul_f32 v50, v50, v98
    ds_read_b64_tr_b16 v[168:169], v21 offset:32768
    ds_read_b64_tr_b16 v[170:171], v21 offset:33280
    s_waitcnt lgkmcnt(8)
    v_mfma_f32_16x16x32_bf16 v[64:67], v[216:219], v[40:43], v[64:67]
    v_mfma_f32_16x16x32_bf16 v[72:75], v[220:223], v[40:43], v[72:75]
    ds_read_b128 v[36:39], v15 offset:10240
    v_mul_f32 v51, v51, v99
    v_mul_f32 v52, v52, v100
    v_mul_f32 v53, v53, v101
    buffer_load_dwordx4 v11, s[32:35], s78 offen offset:1024 lds
    ds_read_b64_tr_b16 v[172:173], v22 offset:32768
    ds_read_b64_tr_b16 v[174:175], v22 offset:33280
    s_waitcnt lgkmcnt(8)
    v_mfma_f32_16x16x32_bf16 v[68:71], v[216:219], v[44:47], v[68:71]
    v_mfma_f32_16x16x32_bf16 v[76:79], v[220:223], v[44:47], v[76:79]
    ds_read_b128 v[40:43], v17 offset:8192
    v_mul_f32 v54, v54, v102
    v_mul_f32 v55, v55, v103
    v_cvt_pk_bf16_f32 v60, v48, v49
    s_waitcnt lgkmcnt(6)
    v_mfma_f32_16x16x32_bf16 v[64:67], v[224:227], v[32:35], v[64:67]
    v_mfma_f32_16x16x32_bf16 v[72:75], v[228:231], v[32:35], v[72:75]
    ds_read_b128 v[44:47], v17 offset:10240
    v_cvt_pk_bf16_f32 v62, v52, v53
    v_cvt_pk_bf16_f32 v61, v50, v51
    v_cvt_pk_bf16_f32 v63, v54, v55
    buffer_load_dwordx4 v12, s[32:35], s78 offen offset:2048 lds
    s_waitcnt vmcnt(3)
    ds_read_b64_tr_b16 v[176:177], v19 offset:0
    ds_read_b64_tr_b16 v[178:179], v19 offset:512
    s_waitcnt lgkmcnt(6)
    v_mfma_f32_16x16x32_bf16 v[68:71], v[224:227], v[36:39], v[68:71]
    v_mfma_f32_16x16x32_bf16 v[76:79], v[228:231], v[36:39], v[76:79]
    ds_read_b128 v[32:35], v15 offset:12288
    v_permlane32_swap_b32 v60, v62
    v_min_u32 v60, -2, v60
    v_permlane32_swap_b32 v61, v63
    s_lshl_b32 s58, s50, 7
    s_load_dwordx4 s[80:83], s[16:17], s58
    s_lshl_b32 s58, s48, 7
    s_load_dwordx4 s[84:87], s[16:17], s58
    ds_read_b64_tr_b16 v[180:181], v20 offset:0
    ds_read_b64_tr_b16 v[182:183], v20 offset:512
    s_waitcnt lgkmcnt(6)
    v_mfma_f32_16x16x32_bf16 v[64:67], v[232:235], v[40:43], v[64:67]
    v_mfma_f32_16x16x32_bf16 v[72:75], v[236:239], v[40:43], v[72:75]
    ds_read_b128 v[36:39], v15 offset:14336
    v_min_u32 v62, -2, v62
    v_min_u32 v61, -2, v61
    v_min_u32 v63, -2, v63
    buffer_load_dwordx4 v13, s[32:35], s78 offen offset:3072 lds
    ds_read_b64_tr_b16 v[184:185], v21 offset:0
    ds_read_b64_tr_b16 v[186:187], v21 offset:512
    s_waitcnt lgkmcnt(8)
    v_mfma_f32_16x16x32_bf16 v[68:71], v[232:235], v[44:47], v[68:71]
    v_mfma_f32_16x16x32_bf16 v[76:79], v[236:239], v[44:47], v[76:79]
    ds_read_b128 v[40:43], v17 offset:12288
    ds_read_b64_tr_b16 v[188:189], v22 offset:0
    ds_read_b64_tr_b16 v[190:191], v22 offset:512
    s_waitcnt lgkmcnt(8)
    v_mfma_f32_16x16x32_bf16 v[64:67], v[240:243], v[32:35], v[64:67]
    v_mfma_f32_16x16x32_bf16 v[72:75], v[244:247], v[32:35], v[72:75]
    ds_read_b128 v[44:47], v17 offset:14336
    s_waitcnt lgkmcnt(6)
    v_mfma_f32_16x16x32_bf16 v[68:71], v[240:243], v[36:39], v[68:71]
    v_mfma_f32_16x16x32_bf16 v[76:79], v[244:247], v[36:39], v[76:79]
    s_waitcnt lgkmcnt(3)
    v_mfma_f32_16x16x32_bf16 v[64:67], v[248:251], v[40:43], v[64:67]
    v_mfma_f32_16x16x32_bf16 v[72:75], v[252:255], v[40:43], v[72:75]
    s_waitcnt lgkmcnt(0)
    v_mfma_f32_16x16x32_bf16 v[68:71], v[248:251], v[44:47], v[68:71]
    v_mfma_f32_16x16x32_bf16 v[76:79], v[252:255], v[44:47], v[76:79]
    s_waitcnt lgkmcnt(0)
    s_xor_b64 s[82:83], s[80:81], s[82:83]
    s_xor_b64 s[86:87], s[84:85], s[86:87]
    s_xor_b64 s[84:85], s[80:81], s[84:85]
    s_or_b64 s[82:83], s[82:83], s[86:87]
    s_or_b64 s[82:83], s[82:83], s[84:85]
    s_xor_b32 s80, s80, s0
    s_xor_b32 s81, s81, s0
    s_or_b64 s[82:83], s[82:83], s[80:81]
    s_cbranch_scc1 L_vp_4_spin
L_vp_4_ok:
    s_add_u32 s58, s62, 458752
    buffer_store_dwordx4 v[60:63], v28, s[40:43], s58 offen sc1
    s_add_u32 m0, s55, 32768
    s_nop 0
    buffer_load_dwordx4 v10, s[32:35], s79 offen offset:0 lds
    s_nop 9
    v_mul_f32 v48, v64, v64
    v_mul_f32 v49, v65, v65
    s_load_dword s80, s[14:15], 32768
    s_load_dword s81, s[14:15], 32832
    s_load_dword s82, s[14:15], 32896
    s_load_dword s83, s[14:15], 32960
    v_mul_f32 v50, v66, v66
    v_mul_f32 v51, v67, v67
    v_mul_f32 v52, v68, v68
    v_mul_f32 v53, v69, v69
    v_mul_f32 v54, v70, v70
    v_mul_f32 v55, v71, v71
    v_fma_f32 v48, v48, s59, v24
    v_fma_f32 v49, v49, s59, v24
    v_fma_f32 v50, v50, s59, v24
    v_fma_f32 v51, v51, s59, v24
    v_fma_f32 v52, v52, s59, v24
    buffer_load_dwordx4 v11, s[32:35], s79 offen offset:1024 lds
    v_fma_f32 v53, v53, s59, v24
    v_fma_f32 v54, v54, s59, v24
    v_fma_f32 v55, v55, s59, v24
    v_mul_f32 v48, v48, v64
    v_mul_f32 v49, v49, v65
    v_mul_f32 v50, v50, v66
    v_mul_f32 v51, v51, v67
    v_mul_f32 v52, v52, v68
    v_mul_f32 v53, v53, v69
    v_mul_f32 v54, v54, v70
    v_mul_f32 v55, v55, v71
    v_exp_f32 v48, v48
    buffer_load_dwordx4 v12, s[32:35], s79 offen offset:2048 lds
    v_mul_f32 v64, v64, v72
    v_exp_f32 v49, v49
    v_mul_f32 v65, v65, v73
    v_exp_f32 v50, v50
    v_mul_f32 v66, v66, v74
    v_exp_f32 v51, v51
    v_mul_f32 v67, v67, v75
    v_exp_f32 v52, v52
    v_mul_f32 v68, v68, v76
    v_exp_f32 v53, v53
    v_mul_f32 v69, v69, v77
    v_exp_f32 v54, v54
    v_mul_f32 v70, v70, v78
    buffer_load_dwordx4 v13, s[32:35], s79 offen offset:3072 lds
    v_exp_f32 v55, v55
    v_mul_f32 v71, v71, v79
    v_add_f32 v48, 1.0, v48
    v_add_f32 v49, 1.0, v49
    v_add_f32 v50, 1.0, v50
    v_add_f32 v51, 1.0, v51
    v_add_f32 v52, 1.0, v52
    v_add_f32 v53, 1.0, v53
    v_add_f32 v54, 1.0, v54
    v_add_f32 v55, 1.0, v55
    v_rcp_f32 v48, v48
    v_rcp_f32 v49, v49
    s_waitcnt lgkmcnt(0)
    s_xor_b64 s[82:83], s[80:81], s[82:83]
    s_xor_b32 s80, s80, s0
    s_xor_b32 s81, s81, s0
    s_or_b64 s[82:83], s[82:83], s[80:81]
    s_cbranch_scc1 L_vp_5_spin
L_vp_5_ok:
    buffer_load_dwordx4 v[80:83], v2, s[40:43], s66 offen sc1
    v_rcp_f32 v50, v50
    v_rcp_f32 v51, v51
    v_rcp_f32 v52, v52
    v_rcp_f32 v53, v53
    v_rcp_f32 v54, v54
    v_rcp_f32 v55, v55
    v_mul_f32 v48, v48, v64
    v_mul_f32 v49, v49, v65
    v_mul_f32 v50, v50, v66
    v_mul_f32 v51, v51, v67
    v_mul_f32 v52, v52, v68
    v_mul_f32 v53, v53, v69
    buffer_load_dwordx4 v[84:87], v2, s[40:43], s67 offen sc1
    v_mul_f32 v54, v54, v70
    v_mul_f32 v55, v55, v71
    v_cvt_pk_bf16_f32 v56, v48, v49
    v_cvt_pk_bf16_f32 v58, v52, v53
    v_cvt_pk_bf16_f32 v57, v50, v51
    v_cvt_pk_bf16_f32 v59, v54, v55
    v_permlane32_swap_b32 v56, v58
    v_min_u32 v56, -2, v56
    v_permlane32_swap_b32 v57, v59
    v_min_u32 v58, -2, v58
    v_min_u32 v57, -2, v57
    v_min_u32 v59, -2, v59
    s_add_u32 s58, s62, 688128
    buffer_store_dwordx4 v[56:59], v28, s[40:43], s58 offen sc1
    s_setprio 0
    v_add_u32 v19, 65536, v19
    v_add_u32 v20, 65536, v20
    v_add_u32 v21, 65536, v21
    v_add_u32 v22, 65536, v22
    ds_read_b64_tr_b16 v[192:193], v19 offset:0
    ds_read_b64_tr_b16 v[194:195], v19 offset:512
    ds_read_b64_tr_b16 v[196:197], v20 offset:0
    ds_read_b64_tr_b16 v[198:199], v20 offset:512
    ds_read_b64_tr_b16 v[200:201], v21 offset:0
    ds_read_b64_tr_b16 v[202:203], v21 offset:512
    ds_read_b64_tr_b16 v[204:205], v22 offset:0
    ds_read_b64_tr_b16 v[206:207], v22 offset:512
    s_waitcnt vmcnt(8)
    ds_read_b64_tr_b16 v[208:209], v19 offset:32768
    ds_read_b64_tr_b16 v[210:211], v19 offset:33280
    ds_read_b64_tr_b16 v[212:213], v20 offset:32768
    ds_read_b64_tr_b16 v[214:215], v20 offset:33280
    ds_read_b64_tr_b16 v[216:217], v21 offset:32768
    ds_read_b64_tr_b16 v[218:219], v21 offset:33280
    ds_read_b64_tr_b16 v[220:221], v22 offset:32768
    ds_read_b64_tr_b16 v[222:223], v22 offset:33280
    s_waitcnt vmcnt(3)
    v_add_u32 v19, 4294901760, v19
    v_add_u32 v20, 4294901760, v20
    v_add_u32 v21, 4294901760, v21
    v_add_u32 v22, 4294901760, v22
    ds_read_b64_tr_b16 v[224:225], v19 offset:32768
    ds_read_b64_tr_b16 v[226:227], v19 offset:33280
    ds_read_b64_tr_b16 v[228:229], v20 offset:32768
    ds_read_b64_tr_b16 v[230:231], v20 offset:33280
    ds_read_b64_tr_b16 v[232:233], v21 offset:32768
    ds_read_b64_tr_b16 v[234:235], v21 offset:33280
    ds_read_b64_tr_b16 v[236:237], v22 offset:32768
    ds_read_b64_tr_b16 v[238:239], v22 offset:33280
    s_waitcnt vmcnt(2)
    v_mfma_f32_16x16x32_bf16 v[96:99], v[80:83], v[128:131], 0
    v_mfma_f32_16x16x32_bf16 v[100:103], v[80:83], v[132:135], 0
    v_mfma_f32_16x16x32_bf16 v[104:107], v[80:83], v[136:139], 0
    v_mfma_f32_16x16x32_bf16 v[108:111], v[80:83], v[140:143], 0
    s_waitcnt vmcnt(1)
    v_mfma_f32_16x16x32_bf16 v[96:99], v[84:87], v[144:147], v[96:99]
    v_mfma_f32_16x16x32_bf16 v[100:103], v[84:87], v[148:151], v[100:103]
    buffer_load_dwordx4 v[88:91], v2, s[40:43], s68 offen sc1
    s_load_dword s80, s[14:15], 0
    s_load_dword s81, s[14:15], 64
    s_load_dword s82, s[14:15], 128
    s_load_dword s83, s[14:15], 192
    v_mfma_f32_16x16x32_bf16 v[104:107], v[84:87], v[152:155], v[104:107]
    v_mfma_f32_16x16x32_bf16 v[108:111], v[84:87], v[156:159], v[108:111]
    buffer_load_dwordx4 v[92:95], v2, s[40:43], s69 offen sc1
    buffer_load_dwordx4 v[112:115], v2, s[40:43], s70 offen sc1
    buffer_load_dwordx4 v[116:119], v2, s[40:43], s71 offen sc1
    buffer_load_dwordx4 v[120:123], v2, s[40:43], s72 offen sc1
    s_waitcnt lgkmcnt(0)
    s_xor_b64 s[82:83], s[80:81], s[82:83]
    s_xor_b32 s80, s80, s0
    s_xor_b32 s81, s81, s0
    s_or_b64 s[82:83], s[82:83], s[80:81]
    s_cbranch_scc1 L_vp_6_spin
L_vp_6_ok:
    buffer_load_dwordx4 v[124:127], v3, s[40:43], s66 offen sc1
    s_waitcnt vmcnt(5)
    v_mfma_f32_16x16x32_bf16 v[96:99], v[88:91], v[160:163], v[96:99]
    v_mfma_f32_16x16x32_bf16 v[100:103], v[88:91], v[164:167], v[100:103]
    buffer_load_dwordx4 v[32:35], v3, s[40:43], s67 offen sc1
    v_mfma_f32_16x16x32_bf16 v[104:107], v[88:91], v[168:171], v[104:107]
    v_mfma_f32_16x16x32_bf16 v[108:111], v[88:91], v[172:175], v[108:111]
    s_waitcnt vmcnt(5)
    v_mfma_f32_16x16x32_bf16 v[96:99], v[92:95], v[176:179], v[96:99]
    v_mfma_f32_16x16x32_bf16 v[100:103], v[92:95], v[180:183], v[100:103]
    buffer_load_dwordx4 v[36:39], v3, s[40:43], s68 offen sc1
    v_mfma_f32_16x16x32_bf16 v[104:107], v[92:95], v[184:187], v[104:107]
    v_mfma_f32_16x16x32_bf16 v[108:111], v[92:95], v[188:191], v[108:111]
    s_waitcnt vmcnt(5)
    v_mfma_f32_16x16x32_bf16 v[96:99], v[112:115], v[192:195], v[96:99]
    v_mfma_f32_16x16x32_bf16 v[100:103], v[112:115], v[196:199], v[100:103]
    buffer_load_dwordx4 v[40:43], v3, s[40:43], s69 offen sc1
    v_mfma_f32_16x16x32_bf16 v[104:107], v[112:115], v[200:203], v[104:107]
    v_mfma_f32_16x16x32_bf16 v[108:111], v[112:115], v[204:207], v[108:111]
    s_waitcnt vmcnt(5)
    v_mfma_f32_16x16x32_bf16 v[96:99], v[116:119], v[208:211], v[96:99]
    v_mfma_f32_16x16x32_bf16 v[100:103], v[116:119], v[212:215], v[100:103]
    buffer_load_dwordx4 v[44:47], v3, s[40:43], s70 offen sc1
    v_mfma_f32_16x16x32_bf16 v[104:107], v[116:119], v[216:219], v[104:107]
    v_mfma_f32_16x16x32_bf16 v[108:111], v[116:119], v[220:223], v[108:111]
    s_waitcnt vmcnt(5)
    v_mfma_f32_16x16x32_bf16 v[96:99], v[120:123], v[224:227], v[96:99]
    v_mfma_f32_16x16x32_bf16 v[100:103], v[120:123], v[228:231], v[100:103]
    buffer_load_dwordx4 v[80:83], v3, s[40:43], s71 offen sc1
    v_mfma_f32_16x16x32_bf16 v[104:107], v[120:123], v[232:235], v[104:107]
    v_mfma_f32_16x16x32_bf16 v[108:111], v[120:123], v[236:239], v[108:111]
    s_waitcnt vmcnt(5)
    v_mfma_f32_16x16x32_bf16 v[64:67], v[124:127], v[128:131], 0
    s_add_u32 m0, s55, 0
    v_mfma_f32_16x16x32_bf16 v[68:71], v[124:127], v[132:135], 0
    buffer_load_dwordx4 v[84:87], v3, s[40:43], s72 offen sc1
    v_mfma_f32_16x16x32_bf16 v[72:75], v[124:127], v[136:139], 0
    v_mfma_f32_16x16x32_bf16 v[76:79], v[124:127], v[140:143], 0
    s_waitcnt vmcnt(5)
    v_mfma_f32_16x16x32_bf16 v[64:67], v[32:35], v[144:147], v[64:67]
    ds_write_addtid_b32 v96 offset:0
    v_mfma_f32_16x16x32_bf16 v[68:71], v[32:35], v[148:151], v[68:71]
    ds_write_addtid_b32 v97 offset:256
    buffer_load_dwordx4 v[88:91], v4, s[40:43], s66 offen sc1
    v_mfma_f32_16x16x32_bf16 v[72:75], v[32:35], v[152:155], v[72:75]
    ds_write_addtid_b32 v98 offset:512
    v_mfma_f32_16x16x32_bf16 v[76:79], v[32:35], v[156:159], v[76:79]
    ds_write_addtid_b32 v99 offset:768
    s_waitcnt vmcnt(5)
    v_mfma_f32_16x16x32_bf16 v[64:67], v[36:39], v[160:163], v[64:67]
    ds_write_addtid_b32 v100 offset:1024
    v_mfma_f32_16x16x32_bf16 v[68:71], v[36:39], v[164:167], v[68:71]
    ds_write_addtid_b32 v101 offset:1280
    buffer_load_dwordx4 v[92:95], v4, s[40:43], s67 offen sc1
    v_mfma_f32_16x16x32_bf16 v[72:75], v[36:39], v[168:171], v[72:75]
    ds_write_addtid_b32 v102 offset:1536
    v_mfma_f32_16x16x32_bf16 v[76:79], v[36:39], v[172:175], v[76:79]
    ds_write_addtid_b32 v103 offset:1792
    s_waitcnt vmcnt(5)
    v_mfma_f32_16x16x32_bf16 v[64:67], v[40:43], v[176:179], v[64:67]
    ds_write_addtid_b32 v104 offset:2048
    v_mfma_f32_16x16x32_bf16 v[68:71], v[40:43], v[180:183], v[68:71]
    ds_write_addtid_b32 v105 offset:2304
    buffer_load_dwordx4 v[112:115], v4, s[40:43], s68 offen sc1
    v_mfma_f32_16x16x32_bf16 v[72:75], v[40:43], v[184:187], v[72:75]
    ds_write_addtid_b32 v106 offset:2560
    v_mfma_f32_16x16x32_bf16 v[76:79], v[40:43], v[188:191], v[76:79]
    ds_write_addtid_b32 v107 offset:2816
    s_waitcnt vmcnt(5)
    v_mfma_f32_16x16x32_bf16 v[64:67], v[44:47], v[192:195], v[64:67]
    ds_write_addtid_b32 v108 offset:3072
    v_mfma_f32_16x16x32_bf16 v[68:71], v[44:47], v[196:199], v[68:71]
    ds_write_addtid_b32 v109 offset:3328
    buffer_load_dwordx4 v[116:119], v4, s[40:43], s69 offen sc1
    v_mfma_f32_16x16x32_bf16 v[72:75], v[44:47], v[200:203], v[72:75]
    ds_write_addtid_b32 v110 offset:3584
    v_mfma_f32_16x16x32_bf16 v[76:79], v[44:47], v[204:207], v[76:79]
    ds_write_addtid_b32 v111 offset:3840
    s_waitcnt vmcnt(5)
    v_mfma_f32_16x16x32_bf16 v[64:67], v[80:83], v[208:211], v[64:67]
    v_mfma_f32_16x16x32_bf16 v[68:71], v[80:83], v[212:215], v[68:71]
    buffer_load_dwordx4 v[120:123], v4, s[40:43], s70 offen sc1
    v_mfma_f32_16x16x32_bf16 v[72:75], v[80:83], v[216:219], v[72:75]
    v_mfma_f32_16x16x32_bf16 v[76:79], v[80:83], v[220:223], v[76:79]
    v_lshrrev_b32 v8, 4, v1
    v_and_b32 v9, 15, v1
    v_lshlrev_b32 v6, 10, v8
    v_lshl_add_u32 v6, v9, 4, v6
    s_and_b32 s58, s3, 3
    s_lshl_b32 s53, s58, 8
    v_add_u32 v6, s53, v6
    v_bfe_u32 v7, v1, 2, 2
    v_lshlrev_b32 v7, 12, v7
    v_lshl_add_u32 v7, v8, 5, v7
    v_and_b32 v9, 3, v1
    v_lshl_add_u32 v7, v9, 3, v7
    v_add_u32 v8, 65536, v6
    s_lshl_b32 s53, s58, 10
    s_lshl_b32 s58, s48, 18
    s_add_u32 s53, s53, s58
    s_and_b32 s58, s49, 1
    s_lshl_b32 s58, s58, 14
    s_add_u32 s53, s53, s58
    s_add_u32 s53, s53, s1
    s_mov_b32 s51, 0
    s_mov_b32 s54, 3
    s_waitcnt vmcnt(5)
    v_mfma_f32_16x16x32_bf16 v[64:67], v[84:87], v[224:227], v[64:67]
    v_mfma_f32_16x16x32_bf16 v[68:71], v[84:87], v[228:231], v[68:71]
    buffer_load_dwordx4 v[124:127], v4, s[40:43], s71 offen sc1
    v_mfma_f32_16x16x32_bf16 v[72:75], v[84:87], v[232:235], v[72:75]
    v_mfma_f32_16x16x32_bf16 v[76:79], v[84:87], v[236:239], v[76:79]
    s_waitcnt vmcnt(5)
    s_waitcnt lgkmcnt(0)
    v_mfma_f32_16x16x32_bf16 v[96:99], v[88:91], v[128:131], 0
    v_max_u32 v30, v88, v89
    s_add_u32 m0, s55, 32768
    v_mfma_f32_16x16x32_bf16 v[100:103], v[88:91], v[132:135], 0
    buffer_load_dwordx4 v[32:35], v4, s[40:43], s72 offen sc1
    v_mfma_f32_16x16x32_bf16 v[104:107], v[88:91], v[136:139], 0
    v_max3_u32 v30, v30, v90, v91
    v_mfma_f32_16x16x32_bf16 v[108:111], v[88:91], v[140:143], 0
    s_waitcnt vmcnt(5)
    v_mfma_f32_16x16x32_bf16 v[96:99], v[92:95], v[144:147], v[96:99]
    v_max3_u32 v30, v30, v92, v93
    ds_write_addtid_b32 v64 offset:0
    v_mfma_f32_16x16x32_bf16 v[100:103], v[92:95], v[148:151], v[100:103]
    ds_write_addtid_b32 v65 offset:256
    buffer_load_dwordx4 v[36:39], v5, s[40:43], s66 offen sc1
    v_mfma_f32_16x16x32_bf16 v[104:107], v[92:95], v[152:155], v[104:107]
    v_max3_u32 v30, v30, v94, v95
    ds_write_addtid_b32 v66 offset:512
    v_mfma_f32_16x16x32_bf16 v[108:111], v[92:95], v[156:159], v[108:111]
    ds_write_addtid_b32 v67 offset:768
    s_waitcnt vmcnt(5)
    v_mfma_f32_16x16x32_bf16 v[96:99], v[112:115], v[160:163], v[96:99]
    v_max3_u32 v30, v30, v112, v113
    ds_write_addtid_b32 v68 offset:1024
    v_mfma_f32_16x16x32_bf16 v[100:103], v[112:115], v[164:167], v[100:103]
    ds_write_addtid_b32 v69 offset:1280
    buffer_load_dwordx4 v[40:43], v5, s[40:43], s67 offen sc1
    v_mfma_f32_16x16x32_bf16 v[104:107], v[112:115], v[168:171], v[104:107]
    v_max3_u32 v30, v30, v114, v115
    ds_write_addtid_b32 v70 offset:1536
    v_mfma_f32_16x16x32_bf16 v[108:111], v[112:115], v[172:175], v[108:111]
    ds_write_addtid_b32 v71 offset:1792
    s_waitcnt vmcnt(5)
    v_mfma_f32_16x16x32_bf16 v[96:99], v[116:119], v[176:179], v[96:99]
    v_max3_u32 v30, v30, v116, v117
    ds_write_addtid_b32 v72 offset:2048
    v_mfma_f32_16x16x32_bf16 v[100:103], v[116:119], v[180:183], v[100:103]
    ds_write_addtid_b32 v73 offset:2304
    buffer_load_dwordx4 v[44:47], v5, s[40:43], s68 offen sc1
    v_mfma_f32_16x16x32_bf16 v[104:107], v[116:119], v[184:187], v[104:107]
    v_max3_u32 v30, v30, v118, v119
    ds_write_addtid_b32 v74 offset:2560
    v_mfma_f32_16x16x32_bf16 v[108:111], v[116:119], v[188:191], v[108:111]
    ds_write_addtid_b32 v75 offset:2816
    s_waitcnt vmcnt(5)
    v_mfma_f32_16x16x32_bf16 v[96:99], v[120:123], v[192:195], v[96:99]
    v_max3_u32 v30, v30, v120, v121
    ds_write_addtid_b32 v76 offset:3072
    v_mfma_f32_16x16x32_bf16 v[100:103], v[120:123], v[196:199], v[100:103]
    ds_write_addtid_b32 v77 offset:3328
    buffer_load_dwordx4 v[80:83], v5, s[40:43], s69 offen sc1
    v_mfma_f32_16x16x32_bf16 v[104:107], v[120:123], v[200:203], v[104:107]
    v_max3_u32 v30, v30, v122, v123
    ds_write_addtid_b32 v78 offset:3584
    v_mfma_f32_16x16x32_bf16 v[108:111], v[120:123], v[204:207], v[108:111]
    ds_write_addtid_b32 v79 offset:3840
    s_waitcnt vmcnt(5)
    v_mfma_f32_16x16x32_bf16 v[96:99], v[124:127], v[208:211], v[96:99]
    v_max3_u32 v30, v30, v124, v125
    v_mfma_f32_16x16x32_bf16 v[100:103], v[124:127], v[212:215], v[100:103]
    buffer_load_dwordx4 v[84:87], v5, s[40:43], s70 offen sc1
    v_mfma_f32_16x16x32_bf16 v[104:107], v[124:127], v[216:219], v[104:107]
    v_max3_u32 v30, v30, v126, v127
    v_mfma_f32_16x16x32_bf16 v[108:111], v[124:127], v[220:223], v[108:111]
    s_waitcnt vmcnt(5)
    v_mfma_f32_16x16x32_bf16 v[96:99], v[32:35], v[224:227], v[96:99]
    v_max3_u32 v30, v30, v32, v33
    v_mfma_f32_16x16x32_bf16 v[100:103], v[32:35], v[228:231], v[100:103]
    buffer_load_dwordx4 v[88:91], v5, s[40:43], s71 offen sc1
    v_mfma_f32_16x16x32_bf16 v[104:107], v[32:35], v[232:235], v[104:107]
    v_max3_u32 v30, v30, v34, v35
    v_mfma_f32_16x16x32_bf16 v[108:111], v[32:35], v[236:239], v[108:111]
    v_cmp_eq_u32 vcc, -1, v30
    s_cmp_lg_u64 vcc, 0
    s_cselect_b32 s50, 2, 3
    buffer_load_dwordx4 v[92:95], v5, s[40:43], s72 offen sc1
    s_waitcnt lgkmcnt(0)
    s_cmp_lt_u32 s3, 4
    s_cbranch_scc1 L_nob1
    s_barrier
    s_mov_b32 s51, 1
    s_setprio 2
L_nob1:
    s_waitcnt vmcnt(6)
    v_mfma_f32_16x16x32_bf16 v[64:67], v[36:39], v[128:131], 0
    v_max_u32 v30, v36, v37
    s_add_u32 m0, s55, 4092
    v_mfma_f32_16x16x32_bf16 v[68:71], v[36:39], v[132:135], 0
    v_mfma_f32_16x16x32_bf16 v[72:75], v[36:39], v[136:139], 0
    v_max3_u32 v30, v30, v38, v39
    v_mfma_f32_16x16x32_bf16 v[76:79], v[36:39], v[140:143], 0
    s_waitcnt vmcnt(5)
    v_mfma_f32_16x16x32_bf16 v[64:67], v[40:43], v[144:147], v[64:67]
    v_max3_u32 v30, v30, v40, v41
    ds_write_addtid_b32 v96 offset:61444
    v_mfma_f32_16x16x32_bf16 v[68:71], v[40:43], v[148:151], v[68:71]
    ds_write_addtid_b32 v97 offset:61700
    v_mfma_f32_16x16x32_bf16 v[72:75], v[40:43], v[152:155], v[72:75]
    v_max3_u32 v30, v30, v42, v43
    ds_write_addtid_b32 v98 offset:61956
    v_mfma_f32_16x16x32_bf16 v[76:79], v[40:43], v[156:159], v[76:79]
    ds_write_addtid_b32 v99 offset:62212
    s_waitcnt vmcnt(4)
    v_mfma_f32_16x16x32_bf16 v[64:67], v[44:47], v[160:163], v[64:67]
    v_max3_u32 v30, v30, v44, v45
    ds_write_addtid_b32 v100 offset:62468
    v_mfma_f32_16x16x32_bf16 v[68:71], v[44:47], v[164:167], v[68:71]
    ds_write_addtid_b32 v101 offset:62724
    v_mfma_f32_16x16x32_bf16 v[72:75], v[44:47], v[168:171], v[72:75]
    v_max3_u32 v30, v30, v46, v47
    ds_write_addtid_b32 v102 offset:62980
    v_mfma_f32_16x16x32_bf16 v[76:79], v[44:47], v[172:175], v[76:79]
    ds_write_addtid_b32 v103 offset:63236
    s_waitcnt vmcnt(3)
    v_mfma_f32_16x16x32_bf16 v[64:67], v[80:83], v[176:179], v[64:67]
    v_max3_u32 v30, v30, v80, v81
    ds_write_addtid_b32 v104 offset:63492
    v_mfma_f32_16x16x32_bf16 v[68:71], v[80:83], v[180:183], v[68:71]
    ds_write_addtid_b32 v105 offset:63748
    v_mfma_f32_16x16x32_bf16 v[72:75], v[80:83], v[184:187], v[72:75]
    v_max3_u32 v30, v30, v82, v83
    ds_write_addtid_b32 v106 offset:64004
    v_mfma_f32_16x16x32_bf16 v[76:79], v[80:83], v[188:191], v[76:79]
    ds_write_addtid_b32 v107 offset:64260
    s_waitcnt vmcnt(2)
    v_mfma_f32_16x16x32_bf16 v[64:67], v[84:87], v[192:195], v[64:67]
    v_max3_u32 v30, v30, v84, v85
    ds_write_addtid_b32 v108 offset:64516
    v_mfma_f32_16x16x32_bf16 v[68:71], v[84:87], v[196:199], v[68:71]
    ds_write_addtid_b32 v109 offset:64772
    v_mfma_f32_16x16x32_bf16 v[72:75], v[84:87], v[200:203], v[72:75]
    v_max3_u32 v30, v30, v86, v87
    ds_write_addtid_b32 v110 offset:65028
    v_mfma_f32_16x16x32_bf16 v[76:79], v[84:87], v[204:207], v[76:79]
    ds_write_addtid_b32 v111 offset:65284
    s_waitcnt vmcnt(1)
    v_mfma_f32_16x16x32_bf16 v[64:67], v[88:91], v[208:211], v[64:67]
    v_max3_u32 v30, v30, v88, v89
    v_mfma_f32_16x16x32_bf16 v[68:71], v[88:91], v[212:215], v[68:71]
    v_mfma_f32_16x16x32_bf16 v[72:75], v[88:91], v[216:219], v[72:75]
    v_max3_u32 v30, v30, v90, v91
    v_mfma_f32_16x16x32_bf16 v[76:79], v[88:91], v[220:223], v[76:79]
    s_waitcnt vmcnt(0)
    v_mfma_f32_16x16x32_bf16 v[64:67], v[92:95], v[224:227], v[64:67]
    v_max3_u32 v30, v30, v92, v93
    v_mfma_f32_16x16x32_bf16 v[68:71], v[92:95], v[228:231], v[68:71]
    v_mfma_f32_16x16x32_bf16 v[72:75], v[92:95], v[232:235], v[72:75]
    v_max3_u32 v30, v30, v94, v95
    v_mfma_f32_16x16x32_bf16 v[76:79], v[92:95], v[236:239], v[76:79]
    v_cmp_eq_u32 vcc, -1, v30
    s_nop 0
    s_cbranch_vccnz L_slow
    s_add_u32 m0, s55, 36860
    s_nop 3
    ds_write_addtid_b32 v64 offset:61444
    ds_write_addtid_b32 v65 offset:61700
    ds_write_addtid_b32 v66 offset:61956
    ds_write_addtid_b32 v67 offset:62212
    ds_write_addtid_b32 v68 offset:62468
    ds_write_addtid_b32 v69 offset:62724
    ds_write_addtid_b32 v70 offset:62980
    ds_write_addtid_b32 v71 offset:63236
    ds_write_addtid_b32 v72 offset:63492
    ds_write_addtid_b32 v73 offset:63748
    ds_write_addtid_b32 v74 offset:64004
    ds_write_addtid_b32 v75 offset:64260
    ds_write_addtid_b32 v76 offset:64516
    ds_write_addtid_b32 v77 offset:64772
    ds_write_addtid_b32 v78 offset:65028
    ds_write_addtid_b32 v79 offset:65284
    s_mov_b32 s54, s50
    s_cmp_eq_u32 s50, 2
    s_cbranch_scc1 L_slow
L_fin1:
L_fin0:
    s_waitcnt lgkmcnt(0)
    s_barrier
    s_cmp_lt_u32 s3, 4
    s_cbranch_scc1 L_t0
    ds_read_b128 v[224:227], v8 offset:32768
    ds_read_b128 v[228:231], v8 offset:36864
    ds_read_b128 v[232:235], v8 offset:40960
    ds_read_b128 v[236:239], v8 offset:45056
    ds_read_b128 v[240:243], v8 offset:49152
    ds_read_b128 v[244:247], v8 offset:53248
    ds_read_b128 v[248:251], v8 offset:57344
    ds_read_b128 v[252:255], v8 offset:61440
    s_bfe_u32 s56, s60, 262156
    s_lshl_b32 s56, s56, 15
    s_add_u32 s56, s56, s53
    s_waitcnt lgkmcnt(6)
    v_pk_add_f32 v[224:225], v[224:225], v[228:229]
    v_pk_add_f32 v[226:227], v[226:227], v[230:231]
    s_waitcnt lgkmcnt(4)
    v_pk_add_f32 v[232:233], v[232:233], v[236:237]
    v_pk_add_f32 v[234:235], v[234:235], v[238:239]
    v_pk_add_f32 v[224:225], v[224:225], v[232:233]
    v_pk_add_f32 v[226:227], v[226:227], v[234:235]
    s_waitcnt lgkmcnt(2)
    v_pk_add_f32 v[240:241], v[240:241], v[244:245]
    v_pk_add_f32 v[242:243], v[242:243], v[246:247]
    v_pk_add_f32 v[224:225], v[224:225], v[240:241]
    v_pk_add_f32 v[226:227], v[226:227], v[242:243]
    s_waitcnt lgkmcnt(0)
    v_pk_add_f32 v[248:249], v[248:249], v[252:253]
    v_pk_add_f32 v[250:251], v[250:251], v[254:255]
    v_pk_add_f32 v[224:225], v[224:225], v[248:249]
    v_pk_add_f32 v[226:227], v[226:227], v[250:251]
    v_cvt_pk_bf16_f32 v46, v224, v225
    v_cvt_pk_bf16_f32 v47, v226, v227
    buffer_store_dwordx2 v[46:47], v7, s[36:39], s56 offen
    s_endpgm
L_t0:
    ds_read_b128 v[128:131], v6 offset:0
    ds_read_b128 v[132:135], v6 offset:4096
    ds_read_b128 v[136:139], v6 offset:8192
    ds_read_b128 v[140:143], v6 offset:12288
    ds_read_b128 v[144:147], v6 offset:16384
    ds_read_b128 v[148:151], v6 offset:20480
    ds_read_b128 v[152:155], v6 offset:24576
    ds_read_b128 v[156:159], v6 offset:28672
    ds_read_b128 v[160:163], v6 offset:32768
    ds_read_b128 v[164:167], v6 offset:36864
    ds_read_b128 v[168:171], v6 offset:40960
    ds_read_b128 v[172:175], v6 offset:45056
    ds_read_b128 v[176:179], v6 offset:49152
    ds_read_b128 v[180:183], v6 offset:53248
    ds_read_b128 v[184:187], v6 offset:57344
    ds_read_b128 v[188:191], v6 offset:61440
    s_bfe_u32 s56, s60, 262144
    s_lshl_b32 s56, s56, 15
    s_add_u32 s56, s56, s53
    s_waitcnt lgkmcnt(14)
    v_add_f32 v128, v128, v132
    v_add_f32 v129, v129, v133
    v_add_f32 v130, v130, v134
    v_add_f32 v131, v131, v135
    s_waitcnt lgkmcnt(12)
    v_add_f32 v136, v136, v140
    v_add_f32 v137, v137, v141
    v_add_f32 v138, v138, v142
    v_add_f32 v139, v139, v143
    v_add_f32 v128, v128, v136
    v_add_f32 v129, v129, v137
    v_add_f32 v130, v130, v138
    v_add_f32 v131, v131, v139
    s_waitcnt lgkmcnt(10)
    v_add_f32 v144, v144, v148
    v_add_f32 v145, v145, v149
    v_add_f32 v146, v146, v150
    v_add_f32 v147, v147, v151
    v_add_f32 v128, v128, v144
    v_add_f32 v129, v129, v145
    v_add_f32 v130, v130, v146
    v_add_f32 v131, v131, v147
    s_waitcnt lgkmcnt(8)
    v_add_f32 v152, v152, v156
    v_add_f32 v153, v153, v157
    v_add_f32 v154, v154, v158
    v_add_f32 v155, v155, v159
    v_add_f32 v128, v128, v152
    v_add_f32 v129, v129, v153
    v_add_f32 v130, v130, v154
    v_add_f32 v131, v131, v155
    v_cvt_pk_bf16_f32 v40, v128, v129
    v_cvt_pk_bf16_f32 v41, v130, v131
    buffer_store_dwordx2 v[40:41], v7, s[36:39], s56 offen
    s_bfe_u32 s56, s60, 262148
    s_lshl_b32 s56, s56, 15
    s_add_u32 s56, s56, s53
    s_waitcnt lgkmcnt(6)
    v_add_f32 v160, v160, v164
    v_add_f32 v161, v161, v165
    v_add_f32 v162, v162, v166
    v_add_f32 v163, v163, v167
    s_waitcnt lgkmcnt(4)
    v_add_f32 v168, v168, v172
    v_add_f32 v169, v169, v173
    v_add_f32 v170, v170, v174
    v_add_f32 v171, v171, v175
    v_add_f32 v160, v160, v168
    v_add_f32 v161, v161, v169
    v_add_f32 v162, v162, v170
    v_add_f32 v163, v163, v171
    s_waitcnt lgkmcnt(2)
    v_add_f32 v176, v176, v180
    v_add_f32 v177, v177, v181
    v_add_f32 v178, v178, v182
    v_add_f32 v179, v179, v183
    v_add_f32 v160, v160, v176
    v_add_f32 v161, v161, v177
    v_add_f32 v162, v162, v178
    v_add_f32 v163, v163, v179
    s_waitcnt lgkmcnt(0)
    v_add_f32 v184, v184, v188
    v_add_f32 v185, v185, v189
    v_add_f32 v186, v186, v190
    v_add_f32 v187, v187, v191
    v_add_f32 v160, v160, v184
    v_add_f32 v161, v161, v185
    v_add_f32 v162, v162, v186
    v_add_f32 v163, v163, v187
    v_cvt_pk_bf16_f32 v42, v160, v161
    v_cvt_pk_bf16_f32 v43, v162, v163
    buffer_store_dwordx2 v[42:43], v7, s[36:39], s56 offen
    s_barrier
    ds_read_b128 v[192:195], v8 offset:0
    ds_read_b128 v[196:199], v8 offset:4096
    ds_read_b128 v[200:203], v8 offset:8192
    ds_read_b128 v[204:207], v8 offset:12288
    ds_read_b128 v[208:211], v8 offset:16384
    ds_read_b128 v[212:215], v8 offset:20480
    ds_read_b128 v[216:219], v8 offset:24576
    ds_read_b128 v[220:223], v8 offset:28672
    s_bfe_u32 s56, s60, 262152
    s_lshl_b32 s56, s56, 15
    s_add_u32 s56, s56, s53
    s_waitcnt lgkmcnt(6)
    v_pk_add_f32 v[192:193], v[192:193], v[196:197]
    v_pk_add_f32 v[194:195], v[194:195], v[198:199]
    s_waitcnt lgkmcnt(4)
    v_pk_add_f32 v[200:201], v[200:201], v[204:205]
    v_pk_add_f32 v[202:203], v[202:203], v[206:207]
    v_pk_add_f32 v[192:193], v[192:193], v[200:201]
    v_pk_add_f32 v[194:195], v[194:195], v[202:203]
    s_waitcnt lgkmcnt(2)
    v_pk_add_f32 v[208:209], v[208:209], v[212:213]
    v_pk_add_f32 v[210:211], v[210:211], v[214:215]
    v_pk_add_f32 v[192:193], v[192:193], v[208:209]
    v_pk_add_f32 v[194:195], v[194:195], v[210:211]
    s_waitcnt lgkmcnt(0)
    v_pk_add_f32 v[216:217], v[216:217], v[220:221]
    v_pk_add_f32 v[218:219], v[218:219], v[222:223]
    v_pk_add_f32 v[192:193], v[192:193], v[216:217]
    v_pk_add_f32 v[194:195], v[194:195], v[218:219]
    v_cvt_pk_bf16_f32 v44, v192, v193
    v_cvt_pk_bf16_f32 v45, v194, v195
    buffer_store_dwordx2 v[44:45], v7, s[36:39], s56 offen
L_done:
L_end:
    s_endpgm
L_idle:
    s_waitcnt vmcnt(0)
    s_barrier
    s_lshl_b32 s58, s48, 2
    s_and_b32 s57, s49, 3
    s_add_u32 s58, s58, s57
    s_lshl_b32 s58, s58, 3
    s_add_u32 s58, s58, s3
    s_mul_i32 s58, s58, 7168
    s_add_u32 s57, s58, 4096
    buffer_load_dwordx4 v[192:195], v23, s[32:35], s58 offen offset:0
    buffer_load_dwordx4 v[196:199], v23, s[32:35], s58 offen offset:1024
    buffer_load_dwordx4 v[200:203], v23, s[32:35], s58 offen offset:2048
    buffer_load_dwordx4 v[204:207], v23, s[32:35], s58 offen offset:3072
    buffer_load_dwordx4 v[208:211], v23, s[32:35], s57 offen offset:0
    buffer_load_dwordx4 v[212:215], v23, s[32:35], s57 offen offset:1024
    buffer_load_dwordx4 v[216:219], v23, s[32:35], s57 offen offset:2048
    s_lshl_b32 s56, s48, 3
    s_and_b32 s57, s49, 2
    s_add_u32 s56, s56, s57
    s_add_u32 s56, s56, 1
    s_mul_i32 s56, s56, 112
    s_and_b32 s57, s49, 1
    s_lshl_b32 s57, s57, 3
    s_add_u32 s57, s57, s3
    s_mul_i32 s57, s57, 7
    s_add_u32 s56, s56, s57
    s_lshl_b32 s56, s56, 10
    buffer_load_dword v31, off, s[44:47], 0 sc1
    s_lshl_b32 s56, s48, 3
    s_and_b32 s57, s49, 3
    s_add_u32 s56, s56, s57
    s_add_u32 s56, s56, 4
    s_mul_i32 s56, s56, 112
    s_mul_i32 s57, s3, 14
    s_add_u32 s56, s56, s57
    s_lshl_b32 s56, s56, 10
    buffer_store_dwordx4 v[124:127], v23, s[40:43], s56 offen offset:0 sc1
    buffer_store_dwordx4 v[124:127], v23, s[40:43], s56 offen offset:1024 sc1
    buffer_store_dwordx4 v[124:127], v23, s[40:43], s56 offen offset:2048 sc1
    buffer_store_dwordx4 v[124:127], v23, s[40:43], s56 offen offset:3072 sc1
    s_add_u32 s56, s56, 4096
    buffer_store_dwordx4 v[124:127], v23, s[40:43], s56 offen offset:0 sc1
    buffer_store_dwordx4 v[124:127], v23, s[40:43], s56 offen offset:1024 sc1
    buffer_store_dwordx4 v[124:127], v23, s[40:43], s56 offen offset:2048 sc1
    buffer_store_dwordx4 v[124:127], v23, s[40:43], s56 offen offset:3072 sc1
    s_add_u32 s56, s56, 4096
    buffer_store_dwordx4 v[124:127], v23, s[40:43], s56 offen offset:0 sc1
    buffer_store_dwordx4 v[124:127], v23, s[40:43], s56 offen offset:1024 sc1
    buffer_store_dwordx4 v[124:127], v23, s[40:43], s56 offen offset:2048 sc1
    buffer_store_dwordx4 v[124:127], v23, s[40:43], s56 offen offset:3072 sc1
    s_add_u32 s56, s56, 4096
    buffer_store_dwordx4 v[124:127], v23, s[40:43], s56 offen offset:0 sc1
    buffer_store_dwordx4 v[124:127], v23, s[40:43], s56 offen offset:1024 sc1
    s_waitcnt vmcnt(0)
    s_waitcnt vmcnt(0)
    v_cmp_eq_u32 vcc, 0, v31
    s_cbranch_vccnz L_ini_7_spin
L_ini_7_ok:
    v_readfirstlane_b32 s0, v31
    s_barrier
    s_lshl_b32 s58, s48, 5
    s_and_b32 s57, s49, 3
    s_add_u32 s58, s58, s57
    s_lshl_b32 s58, s58, 2
    s_cmp_lg_u32 s3, 0
    s_cbranch_scc1 L_noini
    s_atomic_swap s0, s[16:17], s58
L_noini:
    s_add_u32 m0, s55, 65536
    s_nop 0
    buffer_load_dwordx4 v10, s[32:35], s73 offen offset:0 lds
    buffer_load_dwordx4 v11, s[32:35], s73 offen offset:1024 lds
    buffer_load_dwordx4 v12, s[32:35], s73 offen offset:2048 lds
    buffer_load_dwordx4 v13, s[32:35], s73 offen offset:3072 lds
    s_add_u32 m0, s55, 98304
    s_nop 0
    buffer_load_dwordx4 v10, s[32:35], s74 offen offset:0 lds
    buffer_load_dwordx4 v11, s[32:35], s74 offen offset:1024 lds
    buffer_load_dwordx4 v12, s[32:35], s74 offen offset:2048 lds
    buffer_load_dwordx4 v13, s[32:35], s74 offen offset:3072 lds
    s_add_u32 m0, s55, 32768
    s_nop 0
    buffer_load_dwordx4 v10, s[32:35], s75 offen offset:0 lds
    buffer_load_dwordx4 v11, s[32:35], s75 offen offset:1024 lds
    buffer_load_dwordx4 v12, s[32:35], s75 offen offset:2048 lds
    buffer_load_dwordx4 v13, s[32:35], s75 offen offset:3072 lds
    s_add_u32 m0, s55, 0
    s_nop 0
    buffer_load_dwordx4 v10, s[32:35], s76 offen offset:0 lds
    buffer_load_dwordx4 v11, s[32:35], s76 offen offset:1024 lds
    buffer_load_dwordx4 v12, s[32:35], s76 offen offset:2048 lds
    buffer_load_dwordx4 v13, s[32:35], s76 offen offset:3072 lds
    s_add_u32 m0, s55, 131072
    s_nop 0
    buffer_load_dwordx4 v10, s[32:35], s77 offen offset:0 lds
    buffer_load_dwordx4 v11, s[32:35], s77 offen offset:1024 lds
    buffer_load_dwordx4 v12, s[32:35], s77 offen offset:2048 lds
    buffer_load_dwordx4 v13, s[32:35], s77 offen offset:3072 lds
    v_lshrrev_b32 v8, 4, v1
    v_and_b32 v9, 15, v1
    v_lshlrev_b32 v6, 10, v8
    v_lshl_add_u32 v6, v9, 4, v6
    s_and_b32 s58, s3, 3
    s_lshl_b32 s53, s58, 8
    v_add_u32 v6, s53, v6
    v_bfe_u32 v7, v1, 2, 2
    v_lshlrev_b32 v7, 12, v7
    v_lshl_add_u32 v7, v8, 5, v7
    v_and_b32 v9, 3, v1
    v_lshl_add_u32 v7, v9, 3, v7
    v_add_u32 v8, 65536, v6
    s_lshl_b32 s53, s58, 10
    s_lshl_b32 s58, s48, 18
    s_add_u32 s53, s53, s58
    s_and_b32 s58, s49, 1
    s_lshl_b32 s58, s58, 14
    s_add_u32 s53, s53, s58
    s_add_u32 s53, s53, s1
    s_mov_b32 s51, 0
    s_mov_b32 s54, 3
    s_bfe_u32 s58, s60, 262144
    s_mul_i32 s58, s58, 114688
    s_add_u32 s58, s58, s61
    v_add_u32 v2, s58, v23
    s_bfe_u32 s58, s60, 262148
    s_mul_i32 s58, s58, 114688
    s_add_u32 s58, s58, s61
    v_add_u32 v3, s58, v23
    s_bfe_u32 s58, s60, 262152
    s_mul_i32 s58, s58, 114688
    s_add_u32 s58, s58, s61
    v_add_u32 v4, s58, v23
    s_bfe_u32 s58, s60, 262156
    s_mul_i32 s58, s58, 114688
    s_add_u32 s58, s58, s61
    v_add_u32 v5, s58, v23
    s_waitcnt vmcnt(16)
    v_add_u32 v19, 65536, v19
    v_add_u32 v20, 65536, v20
    v_add_u32 v21, 65536, v21
    v_add_u32 v22, 65536, v22
    ds_read_b64_tr_b16 v[128:129], v19 offset:0
    ds_read_b64_tr_b16 v[130:131], v19 offset:512
    ds_read_b64_tr_b16 v[132:133], v20 offset:0
    ds_read_b64_tr_b16 v[134:135], v20 offset:512
    ds_read_b64_tr_b16 v[136:137], v21 offset:0
    ds_read_b64_tr_b16 v[138:139], v21 offset:512
    ds_read_b64_tr_b16 v[140:141], v22 offset:0
    ds_read_b64_tr_b16 v[142:143], v22 offset:512
    s_waitcnt vmcnt(12)
    ds_read_b64_tr_b16 v[144:145], v19 offset:32768
    ds_read_b64_tr_b16 v[146:147], v19 offset:33280
    ds_read_b64_tr_b16 v[148:149], v20 offset:32768
    ds_read_b64_tr_b16 v[150:151], v20 offset:33280
    ds_read_b64_tr_b16 v[152:153], v21 offset:32768
    ds_read_b64_tr_b16 v[154:155], v21 offset:33280
    ds_read_b64_tr_b16 v[156:157], v22 offset:32768
    ds_read_b64_tr_b16 v[158:159], v22 offset:33280
    s_waitcnt lgkmcnt(0)
    s_add_u32 m0, s55, 65536
    s_nop 0
    buffer_load_dwordx4 v10, s[32:35], s78 offen offset:0 lds
    buffer_load_dwordx4 v11, s[32:35], s78 offen offset:1024 lds
    buffer_load_dwordx4 v12, s[32:35], s78 offen offset:2048 lds
    buffer_load_dwordx4 v13, s[32:35], s78 offen offset:3072 lds
    s_mov_b64 exec, 4095
    buffer_load_dword v25, v29, s[40:43], 0 offen sc1
    s_mov_b64 exec, -1
    s_add_u32 m0, s55, 98304
    s_nop 0
    buffer_load_dwordx4 v10, s[32:35], s79 offen offset:0 lds
    buffer_load_dwordx4 v11, s[32:35], s79 offen offset:1024 lds
    buffer_load_dwordx4 v12, s[32:35], s79 offen offset:2048 lds
    buffer_load_dwordx4 v13, s[32:35], s79 offen offset:3072 lds
    s_waitcnt vmcnt(17)
    v_add_u32 v19, 4294901760, v19
    v_add_u32 v20, 4294901760, v20
    v_add_u32 v21, 4294901760, v21
    v_add_u32 v22, 4294901760, v22
    ds_read_b64_tr_b16 v[160:161], v19 offset:32768
    ds_read_b64_tr_b16 v[162:163], v19 offset:33280
    ds_read_b64_tr_b16 v[164:165], v20 offset:32768
    ds_read_b64_tr_b16 v[166:167], v20 offset:33280
    ds_read_b64_tr_b16 v[168:169], v21 offset:32768
    ds_read_b64_tr_b16 v[170:171], v21 offset:33280
    ds_read_b64_tr_b16 v[172:173], v22 offset:32768
    ds_read_b64_tr_b16 v[174:175], v22 offset:33280
    s_waitcnt vmcnt(13)
    ds_read_b64_tr_b16 v[176:177], v19 offset:0
    ds_read_b64_tr_b16 v[178:179], v19 offset:512
    ds_read_b64_tr_b16 v[180:181], v20 offset:0
    ds_read_b64_tr_b16 v[182:183], v20 offset:512
    ds_read_b64_tr_b16 v[184:185], v21 offset:0
    ds_read_b64_tr_b16 v[186:187], v21 offset:512
    ds_read_b64_tr_b16 v[188:189], v22 offset:0
    ds_read_b64_tr_b16 v[190:191], v22 offset:512
    s_waitcnt vmcnt(9)
    v_add_u32 v19, 131072, v19
    v_add_u32 v20, 131072, v20
    v_add_u32 v21, 131072, v21
    v_add_u32 v22, 131072, v22
    ds_read_b64_tr_b16 v[192:193], v19 offset:0
    ds_read_b64_tr_b16 v[194:195], v19 offset:512
    ds_read_b64_tr_b16 v[196:197], v20 offset:0
    ds_read_b64_tr_b16 v[198:199], v20 offset:512
    ds_read_b64_tr_b16 v[200:201], v21 offset:0
    ds_read_b64_tr_b16 v[202:203], v21 offset:512
    ds_read_b64_tr_b16 v[204:205], v22 offset:0
    ds_read_b64_tr_b16 v[206:207], v22 offset:512
    s_waitcnt vmcnt(4)
    v_cmp_ne_u32 vcc, v31, v25
    s_and_b32 vcc_lo, vcc_lo, 4095
    s_cbranch_scc1 L_vp_8_spin
L_vp_8_ok:
    s_mov_b32 s50, 0
    s_lshl_b32 s57, s48, 2
    buffer_load_dwordx4 v[32:35], v2, s[40:43], s66 offen sc1
    buffer_load_dwordx4 v[36:39], v2, s[40:43], s67 offen sc1
    buffer_load_dwordx4 v[40:43], v2, s[40:43], s68 offen sc1
    buffer_load_dwordx4 v[44:47], v2, s[40:43], s69 offen sc1
    v_add_u32 v19, 4294901760, v19
    v_add_u32 v20, 4294901760, v20
    v_add_u32 v21, 4294901760, v21
    v_add_u32 v22, 4294901760, v22
    ds_read_b64_tr_b16 v[208:209], v19 offset:0
    ds_read_b64_tr_b16 v[210:211], v19 offset:512
    ds_read_b64_tr_b16 v[212:213], v20 offset:0
    ds_read_b64_tr_b16 v[214:215], v20 offset:512
    ds_read_b64_tr_b16 v[216:217], v21 offset:0
    ds_read_b64_tr_b16 v[218:219], v21 offset:512
    ds_read_b64_tr_b16 v[220:221], v22 offset:0
    ds_read_b64_tr_b16 v[222:223], v22 offset:512
    s_waitcnt vmcnt(4)
    ds_read_b64_tr_b16 v[224:225], v19 offset:32768
    ds_read_b64_tr_b16 v[226:227], v19 offset:33280
    ds_read_b64_tr_b16 v[228:229], v20 offset:32768
    ds_read_b64_tr_b16 v[230:231], v20 offset:33280
    ds_read_b64_tr_b16 v[232:233], v21 offset:32768
    ds_read_b64_tr_b16 v[234:235], v21 offset:33280
    ds_read_b64_tr_b16 v[236:237], v22 offset:32768
    ds_read_b64_tr_b16 v[238:239], v22 offset:33280
    buffer_load_dwordx4 v[48:51], v2, s[40:43], s70 offen sc1
    buffer_load_dwordx4 v[52:55], v2, s[40:43], s71 offen sc1
    buffer_load_dwordx4 v[56:59], v2, s[40:43], s72 offen sc1
    s_waitcnt vmcnt(6)
    v_mfma_f32_16x16x32_bf16 v[64:67], v[32:35], v[128:131], 0
    v_mfma_f32_16x16x32_bf16 v[68:71], v[32:35], v[132:135], 0
    v_mfma_f32_16x16x32_bf16 v[72:75], v[32:35], v[136:139], 0
    v_mfma_f32_16x16x32_bf16 v[76:79], v[32:35], v[140:143], 0
    buffer_load_dwordx4 v[60:63], v3, s[40:43], s66 offen sc1
    s_waitcnt vmcnt(6)
    v_mfma_f32_16x16x32_bf16 v[64:67], v[36:39], v[144:147], v[64:67]
    v_mfma_f32_16x16x32_bf16 v[68:71], v[36:39], v[148:151], v[68:71]
    v_mfma_f32_16x16x32_bf16 v[72:75], v[36:39], v[152:155], v[72:75]
    v_mfma_f32_16x16x32_bf16 v[76:79], v[36:39], v[156:159], v[76:79]
    buffer_load_dwordx4 v[32:35], v3, s[40:43], s67 offen sc1
    s_waitcnt vmcnt(6)
    s_waitcnt lgkmcnt(15)
    v_mfma_f32_16x16x32_bf16 v[64:67], v[40:43], v[160:163], v[64:67]
    v_mfma_f32_16x16x32_bf16 v[68:71], v[40:43], v[164:167], v[68:71]
    v_mfma_f32_16x16x32_bf16 v[72:75], v[40:43], v[168:171], v[72:75]
    v_mfma_f32_16x16x32_bf16 v[76:79], v[40:43], v[172:175], v[76:79]
    buffer_load_dwordx4 v[36:39], v3, s[40:43], s68 offen sc1
    s_waitcnt vmcnt(6)
    v_mfma_f32_16x16x32_bf16 v[64:67], v[44:47], v[176:179], v[64:67]
    v_mfma_f32_16x16x32_bf16 v[68:71], v[44:47], v[180:183], v[68:71]
    v_mfma_f32_16x16x32_bf16 v[72:75], v[44:47], v[184:187], v[72:75]
    v_mfma_f32_16x16x32_bf16 v[76:79], v[44:47], v[188:191], v[76:79]
    buffer_load_dwordx4 v[40:43], v3, s[40:43], s69 offen sc1
    s_waitcnt vmcnt(6)
    v_mfma_f32_16x16x32_bf16 v[64:67], v[48:51], v[192:195], v[64:67]
    v_mfma_f32_16x16x32_bf16 v[68:71], v[48:51], v[196:199], v[68:71]
    v_mfma_f32_16x16x32_bf16 v[72:75], v[48:51], v[200:203], v[72:75]
    v_mfma_f32_16x16x32_bf16 v[76:79], v[48:51], v[204:207], v[76:79]
    buffer_load_dwordx4 v[44:47], v3, s[40:43], s70 offen sc1
    s_waitcnt vmcnt(6)
    s_waitcnt lgkmcnt(8)
    v_mfma_f32_16x16x32_bf16 v[64:67], v[52:55], v[208:211], v[64:67]
    v_mfma_f32_16x16x32_bf16 v[68:71], v[52:55], v[212:215], v[68:71]
    v_mfma_f32_16x16x32_bf16 v[72:75], v[52:55], v[216:219], v[72:75]
    v_mfma_f32_16x16x32_bf16 v[76:79], v[52:55], v[220:223], v[76:79]
    buffer_load_dwordx4 v[48:51], v3, s[40:43], s71 offen sc1
    s_waitcnt vmcnt(6)
    s_waitcnt lgkmcnt(0)
    v_mfma_f32_16x16x32_bf16 v[64:67], v[56:59], v[224:227], v[64:67]
    v_mfma_f32_16x16x32_bf16 v[68:71], v[56:59], v[228:231], v[68:71]
    v_mfma_f32_16x16x32_bf16 v[72:75], v[56:59], v[232:235], v[72:75]
    v_mfma_f32_16x16x32_bf16 v[76:79], v[56:59], v[236:239], v[76:79]
    buffer_load_dwordx4 v[52:55], v3, s[40:43], s72 offen sc1
    s_waitcnt vmcnt(6)
    v_mfma_f32_16x16x32_bf16 v[80:83], v[60:63], v[128:131], 0
    s_add_u32 m0, s55, 0
    v_mfma_f32_16x16x32_bf16 v[84:87], v[60:63], v[132:135], 0
    v_mfma_f32_16x16x32_bf16 v[88:91], v[60:63], v[136:139], 0
    v_mfma_f32_16x16x32_bf16 v[92:95], v[60:63], v[140:143], 0
    buffer_load_dwordx4 v[56:59], v4, s[40:43], s66 offen sc1
    s_waitcnt vmcnt(6)
    v_mfma_f32_16x16x32_bf16 v[80:83], v[32:35], v[144:147], v[80:83]
    ds_write_addtid_b32 v64 offset:0
    v_mfma_f32_16x16x32_bf16 v[84:87], v[32:35], v[148:151], v[84:87]
    ds_write_addtid_b32 v65 offset:256
    v_mfma_f32_16x16x32_bf16 v[88:91], v[32:35], v[152:155], v[88:91]
    ds_write_addtid_b32 v66 offset:512
    v_mfma_f32_16x16x32_bf16 v[92:95], v[32:35], v[156:159], v[92:95]
    ds_write_addtid_b32 v67 offset:768
    buffer_load_dwordx4 v[60:63], v4, s[40:43], s67 offen sc1
    s_waitcnt vmcnt(6)
    v_mfma_f32_16x16x32_bf16 v[80:83], v[36:39], v[160:163], v[80:83]
    ds_write_addtid_b32 v68 offset:1024
    v_mfma_f32_16x16x32_bf16 v[84:87], v[36:39], v[164:167], v[84:87]
    ds_write_addtid_b32 v69 offset:1280
    v_mfma_f32_16x16x32_bf16 v[88:91], v[36:39], v[168:171], v[88:91]
    ds_write_addtid_b32 v70 offset:1536
    v_mfma_f32_16x16x32_bf16 v[92:95], v[36:39], v[172:175], v[92:95]
    ds_write_addtid_b32 v71 offset:1792
    buffer_load_dwordx4 v[32:35], v4, s[40:43], s68 offen sc1
    s_waitcnt vmcnt(6)
    v_mfma_f32_16x16x32_bf16 v[80:83], v[40:43], v[176:179], v[80:83]
    ds_write_addtid_b32 v72 offset:2048
    v_mfma_f32_16x16x32_bf16 v[84:87], v[40:43], v[180:183], v[84:87]
    ds_write_addtid_b32 v73 offset:2304
    v_mfma_f32_16x16x32_bf16 v[88:91], v[40:43], v[184:187], v[88:91]
    ds_write_addtid_b32 v74 offset:2560
    v_mfma_f32_16x16x32_bf16 v[92:95], v[40:43], v[188:191], v[92:95]
    ds_write_addtid_b32 v75 offset:2816
    buffer_load_dwordx4 v[36:39], v4, s[40:43], s69 offen sc1
    s_waitcnt vmcnt(6)
    v_mfma_f32_16x16x32_bf16 v[80:83], v[44:47], v[192:195], v[80:83]
    ds_write_addtid_b32 v76 offset:3072
    v_mfma_f32_16x16x32_bf16 v[84:87], v[44:47], v[196:199], v[84:87]
    ds_write_addtid_b32 v77 offset:3328
    v_mfma_f32_16x16x32_bf16 v[88:91], v[44:47], v[200:203], v[88:91]
    ds_write_addtid_b32 v78 offset:3584
    v_mfma_f32_16x16x32_bf16 v[92:95], v[44:47], v[204:207], v[92:95]
    ds_write_addtid_b32 v79 offset:3840
    buffer_load_dwordx4 v[40:43], v4, s[40:43], s70 offen sc1
    s_waitcnt vmcnt(6)
    v_mfma_f32_16x16x32_bf16 v[80:83], v[48:51], v[208:211], v[80:83]
    v_mfma_f32_16x16x32_bf16 v[84:87], v[48:51], v[212:215], v[84:87]
    v_mfma_f32_16x16x32_bf16 v[88:91], v[48:51], v[216:219], v[88:91]
    v_mfma_f32_16x16x32_bf16 v[92:95], v[48:51], v[220:223], v[92:95]
    buffer_load_dwordx4 v[44:47], v4, s[40:43], s71 offen sc1
    s_waitcnt vmcnt(6)
    v_mfma_f32_16x16x32_bf16 v[80:83], v[52:55], v[224:227], v[80:83]
    v_mfma_f32_16x16x32_bf16 v[84:87], v[52:55], v[228:231], v[84:87]
    v_mfma_f32_16x16x32_bf16 v[88:91], v[52:55], v[232:235], v[88:91]
    v_mfma_f32_16x16x32_bf16 v[92:95], v[52:55], v[236:239], v[92:95]
    buffer_load_dwordx4 v[48:51], v4, s[40:43], s72 offen sc1
    s_waitcnt vmcnt(6)
    v_mfma_f32_16x16x32_bf16 v[96:99], v[56:59], v[128:131], 0
    v_max_u32 v30, v56, v57
    s_add_u32 m0, s55, 32768
    v_mfma_f32_16x16x32_bf16 v[100:103], v[56:59], v[132:135], 0
    v_mfma_f32_16x16x32_bf16 v[104:107], v[56:59], v[136:139], 0
    v_max3_u32 v30, v30, v58, v59
    v_mfma_f32_16x16x32_bf16 v[108:111], v[56:59], v[140:143], 0
    buffer_load_dwordx4 v[52:55], v5, s[40:43], s66 offen sc1
    s_waitcnt vmcnt(6)
    v_mfma_f32_16x16x32_bf16 v[96:99], v[60:63], v[144:147], v[96:99]
    v_max3_u32 v30, v30, v60, v61
    ds_write_addtid_b32 v80 offset:0
    v_mfma_f32_16x16x32_bf16 v[100:103], v[60:63], v[148:151], v[100:103]
    ds_write_addtid_b32 v81 offset:256
    v_mfma_f32_16x16x32_bf16 v[104:107], v[60:63], v[152:155], v[104:107]
    v_max3_u32 v30, v30, v62, v63
    ds_write_addtid_b32 v82 offset:512
    v_mfma_f32_16x16x32_bf16 v[108:111], v[60:63], v[156:159], v[108:111]
    ds_write_addtid_b32 v83 offset:768
    buffer_load_dwordx4 v[56:59], v5, s[40:43], s67 offen sc1
    s_waitcnt vmcnt(6)
    v_mfma_f32_16x16x32_bf16 v[96:99], v[32:35], v[160:163], v[96:99]
    v_max3_u32 v30, v30, v32, v33
    ds_write_addtid_b32 v84 offset:1024
    v_mfma_f32_16x16x32_bf16 v[100:103], v[32:35], v[164:167], v[100:103]
    ds_write_addtid_b32 v85 offset:1280
    v_mfma_f32_16x16x32_bf16 v[104:107], v[32:35], v[168:171], v[104:107]
    v_max3_u32 v30, v30, v34, v35
    ds_write_addtid_b32 v86 offset:1536
    v_mfma_f32_16x16x32_bf16 v[108:111], v[32:35], v[172:175], v[108:111]
    ds_write_addtid_b32 v87 offset:1792
    buffer_load_dwordx4 v[60:63], v5, s[40:43], s68 offen sc1
    s_waitcnt vmcnt(6)
    v_mfma_f32_16x16x32_bf16 v[96:99], v[36:39], v[176:179], v[96:99]
    v_max3_u32 v30, v30, v36, v37
    ds_write_addtid_b32 v88 offset:2048
    v_mfma_f32_16x16x32_bf16 v[100:103], v[36:39], v[180:183], v[100:103]
    ds_write_addtid_b32 v89 offset:2304
    v_mfma_f32_16x16x32_bf16 v[104:107], v[36:39], v[184:187], v[104:107]
    v_max3_u32 v30, v30, v38, v39
    ds_write_addtid_b32 v90 offset:2560
    v_mfma_f32_16x16x32_bf16 v[108:111], v[36:39], v[188:191], v[108:111]
    ds_write_addtid_b32 v91 offset:2816
    buffer_load_dwordx4 v[32:35], v5, s[40:43], s69 offen sc1
    s_waitcnt vmcnt(6)
    v_mfma_f32_16x16x32_bf16 v[96:99], v[40:43], v[192:195], v[96:99]
    v_max3_u32 v30, v30, v40, v41
    ds_write_addtid_b32 v92 offset:3072
    v_mfma_f32_16x16x32_bf16 v[100:103], v[40:43], v[196:199], v[100:103]
    ds_write_addtid_b32 v93 offset:3328
    v_mfma_f32_16x16x32_bf16 v[104:107], v[40:43], v[200:203], v[104:107]
    v_max3_u32 v30, v30, v42, v43
    ds_write_addtid_b32 v94 offset:3584
    v_mfma_f32_16x16x32_bf16 v[108:111], v[40:43], v[204:207], v[108:111]
    ds_write_addtid_b32 v95 offset:3840
    buffer_load_dwordx4 v[36:39], v5, s[40:43], s70 offen sc1
    s_waitcnt vmcnt(6)
    v_mfma_f32_16x16x32_bf16 v[96:99], v[44:47], v[208:211], v[96:99]
    v_max3_u32 v30, v30, v44, v45
    v_mfma_f32_16x16x32_bf16 v[100:103], v[44:47], v[212:215], v[100:103]
    v_mfma_f32_16x16x32_bf16 v[104:107], v[44:47], v[216:219], v[104:107]
    v_max3_u32 v30, v30, v46, v47
    v_mfma_f32_16x16x32_bf16 v[108:111], v[44:47], v[220:223], v[108:111]
    buffer_load_dwordx4 v[40:43], v5, s[40:43], s71 offen sc1
    s_waitcnt vmcnt(6)
    v_mfma_f32_16x16x32_bf16 v[96:99], v[48:51], v[224:227], v[96:99]
    v_max3_u32 v30, v30, v48, v49
    v_mfma_f32_16x16x32_bf16 v[100:103], v[48:51], v[228:231], v[100:103]
    v_mfma_f32_16x16x32_bf16 v[104:107], v[48:51], v[232:235], v[104:107]
    v_max3_u32 v30, v30, v50, v51
    v_mfma_f32_16x16x32_bf16 v[108:111], v[48:51], v[236:239], v[108:111]
    v_cmp_eq_u32 vcc, -1, v30
    s_cmp_lg_u64 vcc, 0
    s_cselect_b32 s50, 2, 3
    buffer_load_dwordx4 v[44:47], v5, s[40:43], s72 offen sc1
    s_waitcnt vmcnt(6)
    v_mfma_f32_16x16x32_bf16 v[112:115], v[52:55], v[128:131], 0
    v_max_u32 v30, v52, v53
    s_add_u32 m0, s55, 4092
    v_mfma_f32_16x16x32_bf16 v[116:119], v[52:55], v[132:135], 0
    v_mfma_f32_16x16x32_bf16 v[120:123], v[52:55], v[136:139], 0
    v_max3_u32 v30, v30, v54, v55
    v_mfma_f32_16x16x32_bf16 v[124:127], v[52:55], v[140:143], 0
    s_waitcnt lgkmcnt(0)
    s_cmp_lt_u32 s3, 4
    s_cbranch_scc1 L_inob1
    s_barrier
    s_mov_b32 s51, 1
    s_setprio 2
L_inob1:
    s_waitcnt vmcnt(5)
    v_mfma_f32_16x16x32_bf16 v[112:115], v[56:59], v[144:147], v[112:115]
    v_max3_u32 v30, v30, v56, v57
    ds_write_addtid_b32 v96 offset:61444
    v_mfma_f32_16x16x32_bf16 v[116:119], v[56:59], v[148:151], v[116:119]
    ds_write_addtid_b32 v97 offset:61700
    v_mfma_f32_16x16x32_bf16 v[120:123], v[56:59], v[152:155], v[120:123]
    v_max3_u32 v30, v30, v58, v59
    ds_write_addtid_b32 v98 offset:61956
    v_mfma_f32_16x16x32_bf16 v[124:127], v[56:59], v[156:159], v[124:127]
    ds_write_addtid_b32 v99 offset:62212
    s_waitcnt vmcnt(4)
    v_mfma_f32_16x16x32_bf16 v[112:115], v[60:63], v[160:163], v[112:115]
    v_max3_u32 v30, v30, v60, v61
    ds_write_addtid_b32 v100 offset:62468
    v_mfma_f32_16x16x32_bf16 v[116:119], v[60:63], v[164:167], v[116:119]
    ds_write_addtid_b32 v101 offset:62724
    v_mfma_f32_16x16x32_bf16 v[120:123], v[60:63], v[168:171], v[120:123]
    v_max3_u32 v30, v30, v62, v63
    ds_write_addtid_b32 v102 offset:62980
    v_mfma_f32_16x16x32_bf16 v[124:127], v[60:63], v[172:175], v[124:127]
    ds_write_addtid_b32 v103 offset:63236
    s_waitcnt vmcnt(3)
    v_mfma_f32_16x16x32_bf16 v[112:115], v[32:35], v[176:179], v[112:115]
    v_max3_u32 v30, v30, v32, v33
    ds_write_addtid_b32 v104 offset:63492
    v_mfma_f32_16x16x32_bf16 v[116:119], v[32:35], v[180:183], v[116:119]
    ds_write_addtid_b32 v105 offset:63748
    v_mfma_f32_16x16x32_bf16 v[120:123], v[32:35], v[184:187], v[120:123]
    v_max3_u32 v30, v30, v34, v35
    ds_write_addtid_b32 v106 offset:64004
    v_mfma_f32_16x16x32_bf16 v[124:127], v[32:35], v[188:191], v[124:127]
    ds_write_addtid_b32 v107 offset:64260
    s_waitcnt vmcnt(2)
    v_mfma_f32_16x16x32_bf16 v[112:115], v[36:39], v[192:195], v[112:115]
    v_max3_u32 v30, v30, v36, v37
    ds_write_addtid_b32 v108 offset:64516
    v_mfma_f32_16x16x32_bf16 v[116:119], v[36:39], v[196:199], v[116:119]
    ds_write_addtid_b32 v109 offset:64772
    v_mfma_f32_16x16x32_bf16 v[120:123], v[36:39], v[200:203], v[120:123]
    v_max3_u32 v30, v30, v38, v39
    ds_write_addtid_b32 v110 offset:65028
    v_mfma_f32_16x16x32_bf16 v[124:127], v[36:39], v[204:207], v[124:127]
    ds_write_addtid_b32 v111 offset:65284
    s_waitcnt vmcnt(1)
    v_mfma_f32_16x16x32_bf16 v[112:115], v[40:43], v[208:211], v[112:115]
    v_max3_u32 v30, v30, v40, v41
    v_mfma_f32_16x16x32_bf16 v[116:119], v[40:43], v[212:215], v[116:119]
    v_mfma_f32_16x16x32_bf16 v[120:123], v[40:43], v[216:219], v[120:123]
    v_max3_u32 v30, v30, v42, v43
    v_mfma_f32_16x16x32_bf16 v[124:127], v[40:43], v[220:223], v[124:127]
    s_waitcnt vmcnt(0)
    v_mfma_f32_16x16x32_bf16 v[112:115], v[44:47], v[224:227], v[112:115]
    v_max3_u32 v30, v30, v44, v45
    v_mfma_f32_16x16x32_bf16 v[116:119], v[44:47], v[228:231], v[116:119]
    v_mfma_f32_16x16x32_bf16 v[120:123], v[44:47], v[232:235], v[120:123]
    v_max3_u32 v30, v30, v46, v47
    v_mfma_f32_16x16x32_bf16 v[124:127], v[44:47], v[236:239], v[124:127]
    v_cmp_eq_u32 vcc, -1, v30
    s_nop 0
    s_cbranch_vccnz L_slow
    s_add_u32 m0, s55, 36860
    s_nop 3
    ds_write_addtid_b32 v112 offset:61444
    ds_write_addtid_b32 v113 offset:61700
    ds_write_addtid_b32 v114 offset:61956
    ds_write_addtid_b32 v115 offset:62212
    ds_write_addtid_b32 v116 offset:62468
    ds_write_addtid_b32 v117 offset:62724
    ds_write_addtid_b32 v118 offset:62980
    ds_write_addtid_b32 v119 offset:63236
    ds_write_addtid_b32 v120 offset:63492
    ds_write_addtid_b32 v121 offset:63748
    ds_write_addtid_b32 v122 offset:64004
    ds_write_addtid_b32 v123 offset:64260
    ds_write_addtid_b32 v124 offset:64516
    ds_write_addtid_b32 v125 offset:64772
    ds_write_addtid_b32 v126 offset:65028
    ds_write_addtid_b32 v127 offset:65284
    s_mov_b32 s54, s50
    s_cmp_eq_u32 s50, 2
    s_cbranch_scc1 L_slow
    s_branch L_exit
L_slow:
    s_waitcnt lgkmcnt(0)
    s_lshl_b32 s56, s50, 2
    s_lshr_b32 s56, s60, s56
    s_and_b32 s56, s56, 15
    s_mul_i32 s56, s56, 114688
    s_add_u32 s56, s56, s61
    v_add_u32 v31, s56, v23
    buffer_load_dwordx4 v[80:83], v31, s[40:43], s66 offen sc1
    buffer_load_dwordx4 v[84:87], v31, s[40:43], s67 offen sc1
    buffer_load_dwordx4 v[88:91], v31, s[40:43], s68 offen sc1
    buffer_load_dwordx4 v[92:95], v31, s[40:43], s69 offen sc1
    buffer_load_dwordx4 v[112:115], v31, s[40:43], s70 offen sc1
L_loop:
    v_mov_b32 v29, v31
    s_add_u32 s52, s50, 1
    s_min_u32 s52, s52, s54
    s_lshl_b32 s56, s52, 2
    s_lshr_b32 s56, s60, s56
    s_and_b32 s56, s56, 15
    s_mul_i32 s56, s56, 114688
    s_add_u32 s56, s56, s61
    v_add_u32 v31, s56, v23
    s_waitcnt lgkmcnt(0)
    s_waitcnt vmcnt(4)
    v_mfma_f32_16x16x32_bf16 v[64:67], v[80:83], v[128:131], 0
    v_max_u32 v30, v80, v81
    v_mfma_f32_16x16x32_bf16 v[68:71], v[80:83], v[132:135], 0
    v_max3_u32 v30, v30, v82, v83
    buffer_load_dwordx4 v[116:119], v29, s[40:43], s71 offen sc1
    v_mfma_f32_16x16x32_bf16 v[72:75], v[80:83], v[136:139], 0
    v_mfma_f32_16x16x32_bf16 v[76:79], v[80:83], v[140:143], 0
    s_waitcnt vmcnt(4)
    v_mfma_f32_16x16x32_bf16 v[64:67], v[84:87], v[144:147], v[64:67]
    v_max3_u32 v30, v30, v84, v85
    v_mfma_f32_16x16x32_bf16 v[68:71], v[84:87], v[148:151], v[68:71]
    v_max3_u32 v30, v30, v86, v87
    buffer_load_dwordx4 v[120:123], v29, s[40:43], s72 offen sc1
    v_mfma_f32_16x16x32_bf16 v[72:75], v[84:87], v[152:155], v[72:75]
    v_mfma_f32_16x16x32_bf16 v[76:79], v[84:87], v[156:159], v[76:79]
    s_waitcnt vmcnt(4)
    v_mfma_f32_16x16x32_bf16 v[64:67], v[88:91], v[160:163], v[64:67]
    v_max3_u32 v30, v30, v88, v89
    v_mfma_f32_16x16x32_bf16 v[68:71], v[88:91], v[164:167], v[68:71]
    v_max3_u32 v30, v30, v90, v91
    buffer_load_dwordx4 v[80:83], v31, s[40:43], s66 offen sc1
    v_mfma_f32_16x16x32_bf16 v[72:75], v[88:91], v[168:171], v[72:75]
    v_mfma_f32_16x16x32_bf16 v[76:79], v[88:91], v[172:175], v[76:79]
    s_waitcnt vmcnt(4)
    v_mfma_f32_16x16x32_bf16 v[64:67], v[92:95], v[176:179], v[64:67]
    v_max3_u32 v30, v30, v92, v93
    v_mfma_f32_16x16x32_bf16 v[68:71], v[92:95], v[180:183], v[68:71]
    v_max3_u32 v30, v30, v94, v95
    buffer_load_dwordx4 v[84:87], v31, s[40:43], s67 offen sc1
    v_mfma_f32_16x16x32_bf16 v[72:75], v[92:95], v[184:187], v[72:75]
    v_mfma_f32_16x16x32_bf16 v[76:79], v[92:95], v[188:191], v[76:79]
    s_waitcnt vmcnt(4)
    v_mfma_f32_16x16x32_bf16 v[64:67], v[112:115], v[192:195], v[64:67]
    v_max3_u32 v30, v30, v112, v113
    v_mfma_f32_16x16x32_bf16 v[68:71], v[112:115], v[196:199], v[68:71]
    v_max3_u32 v30, v30, v114, v115
    buffer_load_dwordx4 v[88:91], v31, s[40:43], s68 offen sc1
    v_mfma_f32_16x16x32_bf16 v[72:75], v[112:115], v[200:203], v[72:75]
    v_mfma_f32_16x16x32_bf16 v[76:79], v[112:115], v[204:207], v[76:79]
    s_waitcnt vmcnt(4)
    v_mfma_f32_16x16x32_bf16 v[64:67], v[116:119], v[208:211], v[64:67]
    v_max3_u32 v30, v30, v116, v117
    v_mfma_f32_16x16x32_bf16 v[68:71], v[116:119], v[212:215], v[68:71]
    v_max3_u32 v30, v30, v118, v119
    buffer_load_dwordx4 v[92:95], v31, s[40:43], s69 offen sc1
    v_mfma_f32_16x16x32_bf16 v[72:75], v[116:119], v[216:219], v[72:75]
    v_mfma_f32_16x16x32_bf16 v[76:79], v[116:119], v[220:223], v[76:79]
    s_waitcnt vmcnt(4)
    v_mfma_f32_16x16x32_bf16 v[64:67], v[120:123], v[224:227], v[64:67]
    v_max3_u32 v30, v30, v120, v121
    v_mfma_f32_16x16x32_bf16 v[68:71], v[120:123], v[228:231], v[68:71]
    v_max3_u32 v30, v30, v122, v123
    buffer_load_dwordx4 v[112:115], v31, s[40:43], s70 offen sc1
    v_mfma_f32_16x16x32_bf16 v[72:75], v[120:123], v[232:235], v[72:75]
    v_mfma_f32_16x16x32_bf16 v[76:79], v[120:123], v[236:239], v[76:79]
    v_cmp_eq_u32 vcc, -1, v30
    s_and_b32 s56, s50, 1
    s_lshl_b32 s56, s56, 15
    s_add_u32 s56, s56, s55
    s_add_u32 s57, s56, 4092
    s_add_u32 s64, s64, 1
    s_cbranch_vccnz L_bad
L_good:
    s_cmp_ge_u32 s50, 2
    s_cbranch_scc1 L_dumphi
    s_mov_b32 m0, s56
    s_nop 0
    ds_write_addtid_b32 v64 offset:0
    ds_write_addtid_b32 v65 offset:256
    ds_write_addtid_b32 v66 offset:512
    ds_write_addtid_b32 v67 offset:768
    ds_write_addtid_b32 v68 offset:1024
    ds_write_addtid_b32 v69 offset:1280
    ds_write_addtid_b32 v70 offset:1536
    ds_write_addtid_b32 v71 offset:1792
    ds_write_addtid_b32 v72 offset:2048
    ds_write_addtid_b32 v73 offset:2304
    ds_write_addtid_b32 v74 offset:2560
    ds_write_addtid_b32 v75 offset:2816
    ds_write_addtid_b32 v76 offset:3072
    ds_write_addtid_b32 v77 offset:3328
    ds_write_addtid_b32 v78 offset:3584
    ds_write_addtid_b32 v79 offset:3840
    s_branch L_dumped
L_dumphi:
    s_mov_b32 m0, s57
    s_nop 0
    ds_write_addtid_b32 v64 offset:61444
    ds_write_addtid_b32 v65 offset:61700
    ds_write_addtid_b32 v66 offset:61956
    ds_write_addtid_b32 v67 offset:62212
    ds_write_addtid_b32 v68 offset:62468
    ds_write_addtid_b32 v69 offset:62724
    ds_write_addtid_b32 v70 offset:62980
    ds_write_addtid_b32 v71 offset:63236
    ds_write_addtid_b32 v72 offset:63492
    ds_write_addtid_b32 v73 offset:63748
    ds_write_addtid_b32 v74 offset:64004
    ds_write_addtid_b32 v75 offset:64260
    ds_write_addtid_b32 v76 offset:64516
    ds_write_addtid_b32 v77 offset:64772
    ds_write_addtid_b32 v78 offset:65028
    ds_write_addtid_b32 v79 offset:65284
L_dumped:
    s_cmp_eq_u32 s50, s54
    s_mov_b32 s50, s52
    s_cbranch_scc0 L_loop
L_exit:
    s_cmp_lt_u32 s3, 4
    s_cbranch_scc1 L_fin0
    s_cmp_eq_u32 s51, 1
    s_cbranch_scc1 L_fin1
    s_waitcnt lgkmcnt(0)
    s_barrier
    s_branch L_fin1
L_bad:
    s_cmp_ge_u32 s64, 100000
    s_cbranch_scc1 L_good
    s_cmp_eq_u32 s50, s54
    s_cbranch_scc1 L_loop
    s_cmp_lt_u32 s49, 28
    s_cbranch_scc1 L_slow
    s_sleep 3
    s_branch L_slow
L_ini_1_spin:
    buffer_load_dword v31, off, s[44:47], 0 sc1
    s_add_u32 s64, s64, 1
    s_waitcnt vmcnt(0)
    v_cmp_eq_u32 vcc, 0, v31
    s_cmp_lt_u32 s64, 100000
    s_cbranch_vccz L_ini_1_ok
    s_cbranch_scc1 L_ini_1_spin
    s_branch L_ini_1_ok
L_vp_4_spin:
    s_sleep 2
    s_mov_b64 exec, 4080
    buffer_load_dword v25, v29, s[40:43], 0 offen sc1
    s_mov_b64 exec, -1
    s_add_u32 s64, s64, 1
    s_waitcnt vmcnt(0)
    v_cmp_ne_u32 vcc, v31, v25
    s_and_b32 vcc_lo, vcc_lo, 4080
    s_cbranch_scc0 L_vp_4_ok
    s_cmp_lt_u32 s64, 100000
    s_cbranch_scc1 L_vp_4_spin
    s_branch L_vp_4_ok
L_vp_5_spin:
    s_sleep 2
    s_mov_b64 exec, 15
    buffer_load_dword v25, v29, s[40:43], 0 offen sc1
    s_mov_b64 exec, -1
    s_add_u32 s64, s64, 1
    s_waitcnt vmcnt(0)
    v_cmp_ne_u32 vcc, v31, v25
    s_and_b32 vcc_lo, vcc_lo, 15
    s_cbranch_scc0 L_vp_5_ok
    s_cmp_lt_u32 s64, 100000
    s_cbranch_scc1 L_vp_5_spin
    s_branch L_vp_5_ok
L_vp_6_spin:
    s_sleep 2
    s_mov_b64 exec, 15
    buffer_load_dword v25, v29, s[40:43], 0 offen sc1
    s_mov_b64 exec, -1
    s_add_u32 s64, s64, 1
    s_waitcnt vmcnt(0)
    v_cmp_ne_u32 vcc, v31, v25
    s_and_b32 vcc_lo, vcc_lo, 15
    s_cbranch_scc0 L_vp_6_ok
    s_cmp_lt_u32 s64, 100000
    s_cbranch_scc1 L_vp_6_spin
    s_branch L_vp_6_ok
L_ini_7_spin:
    buffer_load_dword v31, off, s[44:47], 0 sc1
    s_add_u32 s64, s64, 1
    s_waitcnt vmcnt(0)
    v_cmp_eq_u32 vcc, 0, v31
    s_cmp_lt_u32 s64, 100000
    s_cbranch_vccz L_ini_7_ok
    s_cbranch_scc1 L_ini_7_spin
    s_branch L_ini_7_ok
L_vp_8_spin:
    s_sleep 2
    s_mov_b64 exec, 4095
    buffer_load_dword v25, v29, s[40:43], 0 offen sc1
    s_mov_b64 exec, -1
    s_add_u32 s64, s64, 1
    s_waitcnt vmcnt(0)
    v_cmp_ne_u32 vcc, v31, v25
    s_and_b32 vcc_lo, vcc_lo, 4095
    s_cbranch_scc0 L_vp_8_ok
    s_cmp_lt_u32 s64, 100000
    s_cbranch_scc1 L_vp_8_spin
    s_branch L_vp_8_ok
L_last:
    s_endpgm
.p2align 8
.fill 64, 4, 0xbf800000

.section .rodata,"a"
.p2align 6
.amdhsa_kernel standalone__geglu_ffn__prompt_kernel
  .amdhsa_next_free_vgpr 256
  .amdhsa_next_free_sgpr 102
  .amdhsa_accum_offset 256
  .amdhsa_group_segment_fixed_size 0
  .amdhsa_kernarg_size 56
  .amdhsa_user_sgpr_count 2
  .amdhsa_user_sgpr_kernarg_segment_ptr 1
  .amdhsa_system_sgpr_workgroup_id_x 1
.end_amdhsa_kernel
```
